```python
import torch

def _softmax(x, axis=-1):
    return torch.softmax(x, dim=axis)
def _gelu(x):
    return torch.nn.functional.gelu(x, approximate="tanh")
def _silu(x):
    return torch.nn.functional.silu(x)
def _sigmoid(x):
    return torch.sigmoid(x)
def _layernorm(x, axis=-1, eps=1e-5):
    m = x.mean(dim=axis, keepdim=True)
    v = x.var(dim=axis, keepdim=True, unbiased=False)
    return (x - m) / torch.sqrt(v + eps)
def _scatter_add(tgt, idx, src, axis=0):
    return tgt.clone().index_add_(axis, idx, src)
def _segment_sum(src, seg, n):
    out = torch.zeros((n,) + src.shape[1:], dtype=src.dtype)
    return out.index_add_(0, seg, src)
def _pad(x, pw):
    flat = tuple(v for pair in reversed(pw) for v in pair)
    return torch.nn.functional.pad(x, flat)

kernel_name = 'sequential_preLN__sliding_local_dilated__glu_gated_swiglu__prompt'

def setup_inputs():

    _w = (lambda a: (lambda t: t.to(torch.bfloat16) if t.is_floating_point() else t)(torch.as_tensor(a)))
    def _A_setup():
        B, S, D = 1, 2048, 512
        return {
            "x": _w((lambda *s: torch.randn(*s, dtype=torch.bfloat16) * 0.05)(B, S, D)),
            "wqkv": _w((lambda *s: torch.randn(*s, dtype=torch.bfloat16) * 0.05)(D, 3 * D)),
            "wo": _w((lambda *s: torch.randn(*s, dtype=torch.bfloat16) * 0.05)(D, D)),
        }
    _A_in = _A_setup()

    def _B_setup():
        B, S, D, F = 1, 2048, 512, 1792
        return {
            "x": _w((lambda *s: torch.randn(*s, dtype=torch.bfloat16) * 0.05)(B, S, D)),
            "w1": _w((lambda *s: torch.randn(*s, dtype=torch.bfloat16) * 0.8)(D, F) * (2.0 / D) ** 0.5),
            "w3": _w((lambda *s: torch.randn(*s, dtype=torch.bfloat16) * 0.8)(D, F) * (2.0 / D) ** 0.5),
            "w2": _w((lambda *s: torch.randn(*s, dtype=torch.bfloat16) * 0.8)(F, D) * (2.0 / F) ** 0.5),
        }
    _B_in = _B_setup()

    return {
        "A_x": _A_in["x"],
        "A_wqkv": _A_in["wqkv"],
        "A_wo": _A_in["wo"],
        "B_x": _B_in["x"],
        "B_w1": _B_in["w1"],
        "B_w3": _B_in["w3"],
        "B_w2": _B_in["w2"],
    }

def reference(A_x, A_wqkv, A_wo, B_x, B_w1, B_w3, B_w2):
    def _A_ref(x, wqkv, wo):
        B, S, D = x.shape
        H = 32; Dh = D // H
        W, dil = 8, 2
        qkv = (lambda x, *d: x.permute(*d))((x @ wqkv).reshape(B, S, 3, H, Dh), 2, 0, 3, 1, 4)
        q, k, v = qkv[0], qkv[1], qkv[2]
        scale = Dh ** -0.5
        pos = torch.arange(S)
        off = torch.arange(W) * dil
        idx = pos[:, None] - off[None, :]
        mask = idx >= 0
        idx_c = torch.where(mask, idx, 0).reshape(-1)
        kg = k[:, :, idx_c, :].reshape(B, H, S, W, Dh)
        vg = v[:, :, idx_c, :].reshape(B, H, S, W, Dh)
        logits = torch.einsum("bhsd,bhswd->bhsw", q, kg) * scale
        logits = torch.where(mask[None, None, :, :], logits, -1e9)
        attn = _softmax(logits, axis=-1)
        o = torch.einsum("bhsw,bhswd->bhsd", attn, vg)
        return (lambda x, *d: x.permute(*d))(o, 0, 2, 1, 3).reshape(B, S, D) @ wo

    def _B_ref(x, w1, w3, w2):
        gate = torch.einsum("bsd,df->bsf", x, w1)
        up = torch.einsum("bsd,df->bsf", x, w3)
        h = _silu(gate) * up
        out = torch.einsum("bsf,fd->bsd", h, w2)
        return out

    x = A_x
    h = x + _A_ref(_layernorm(x, axis=-1), A_wqkv, A_wo)
    h2 = h + _B_ref(_layernorm(h, axis=-1), B_w1, B_w3, B_w2)
    return h2
```

```asm
; @launch grid=(256,1,1) block=(512,1,1) lds=163840
.amdgcn_target "amdgcn-amd-amdhsa--gfx950"
.text
.globl sequential_preLN__sliding_local_dilated__glu_gated_swiglu__prompt_kernel
.p2align 8
.type sequential_preLN__sliding_local_dilated__glu_gated_swiglu__prompt_kernel,@function
sequential_preLN__sliding_local_dilated__glu_gated_swiglu__prompt_kernel:
    s_cmp_ge_u32 s2, 256
    s_cbranch_scc1 K_END
    s_load_dwordx16 s[4:19], s[0:1], 0
    s_load_dwordx4 s[20:23], s[0:1], 64
    s_getpc_b64 s[90:91]
CPF_PC:
    v_and_b32 v1, 63, v0
    v_lshrrev_b32 v3, 6, v0
    s_and_b32 s52, s2, 7
    v_readfirstlane_b32 s44, v3
    s_lshr_b32 s53, s2, 3
    v_and_b32 v4, 1, v0
    v_lshl_add_u32 v3, v3, 1, v4
    s_lshl_b32 s48, s53, 11
    v_lshlrev_b32 v3, 7, v3
    v_add_u32 v3, s48, v3
    v_min_u32 v3, K_END-CPF_PC, v3
    global_load_dword v8, v3, s[90:91]
    s_lshr_b32 s54, s52, 1
    s_lshl_b32 s54, s54, 3
    s_lshr_b32 s55, s53, 2
    s_add_u32 s54, s54, s55
    s_and_b32 s55, s52, 1
    s_lshl_b32 s55, s55, 2
    s_and_b32 s48, s53, 3
    s_add_u32 s55, s55, s48
    s_lshr_b32 s56, s54, 1
    s_lshl_b32 s56, s56, 17
    s_and_b32 s48, s54, 1
    s_lshl_b32 s48, s48, 10
    s_add_u32 s56, s56, s48
    s_mul_i32 s48, s53, 49152
    s_and_b32 s49, s52, 1
    s_lshl_b32 s49, s49, 9
    s_add_u32 s48, s48, s49
    s_lshl_b32 s49, s44, 10
    s_add_u32 s48, s48, s49
    s_and_b32 s49, s55, 3
    s_mul_i32 s49, s49, 36864
    s_add_u32 s49, s49, s56
    s_lshl_b32 s50, s44, 14
    s_add_u32 s49, s49, s50
    s_sub_u32 s49, s49, 65536
    s_cmp_gt_u32 s44, 5
    s_cselect_b32 s49, 0x80000000, s49
    s_cmp_eq_u32 s44, 5
    s_cselect_b32 s51, 1, 7
    s_cmp_lt_u32 s44, 3
    s_cselect_b32 s51, 15, s51
    s_cselect_b32 s48, s48, s49
    s_cselect_b32 s49, 2, 3
    s_cselect_b32 s50, 3, 7
    v_lshrrev_b32 v3, s49, v1
    v_min_u32 v3, s51, v3
    s_cselect_b32 s49, 3, 2
    v_and_b32 v4, s50, v1
    v_min_u32 v4, 7, v4
    v_mul_u32_u24 v3, s49, v3
    v_lshlrev_b32 v3, 10, v3
    v_lshl_add_u32 v3, v4, 7, v3
    v_add_u32 v3, s48, v3
    s_mov_b32 s27, 0x20000
    s_mov_b32 s51, 0x180000
    s_cselect_b32 s26, s51, 0x200000
    s_waitcnt lgkmcnt(0)
    s_cselect_b32 s24, s6, s4
    s_cselect_b32 s25, s7, s5
    s_and_b32 s25, s25, 0xffff
    buffer_load_dword v9, v3, s[24:27], 0 offen
    v_lshlrev_b32 v2, 4, v1
    s_mov_b32 s47, 0x3f803f80
    s_and_b32 s45, s44, 3
    v_mov_b32 v11, 152576
    v_mov_b32 v7, 0
    s_cmp_eq_u32 s44, 4
    s_cbranch_scc1 P1_LOAD
    s_cmp_gt_u32 s44, 4
    s_cbranch_scc1 P1_STATS
    v_mov_b32 v148, s47
    v_mov_b32 v149, s47
    v_mov_b32 v150, s47
    v_mov_b32 v151, s47
    s_mul_i32 s48, s44, 34816
    v_add_u32 v5, s48, v2
    ds_write_b128 v5, v[148:151]
    v_and_b32 v12, 15, v1
    v_lshrrev_b32 v13, 4, v1
    v_bfe_u32 v3, v1, 3, 2
    v_xor_b32 v3, s44, v3
    v_lshlrev_b32 v14, 5, v3
    v_mul_u32_u24 v3, 3072, v13
    v_add_u32 v14, v14, v3
    v_bfe_u32 v3, v1, 2, 2
    v_lshl_add_u32 v14, v3, 7, v14
    v_and_b32 v3, 3, v1
    v_lshl_add_u32 v14, v3, 3, v14
    v_add_u32 v14, 10240, v14
    v_add_u32 v15, 69632, v14
    v_lshrrev_b32 v3, 1, v12
    v_xor_b32 v3, v3, v13
    v_lshlrev_b32 v16, 4, v3
    v_lshl_add_u32 v16, v12, 7, v16
    v_xor_b32 v17, 64, v16
    v_add_u32 v18, 69632, v16
    v_add_u32 v19, 69632, v17
    s_mov_b32 s58, 0xf149f2ca
    v_mov_b32 v4, s58
    v_lshlrev_b32 v3, 2, v13
    v_sub_u32 v3, v12, v3
    v_subrev_u32 v5, 0, v3
    v_cmp_gt_u32 vcc, 8, v5
    v_cmp_gt_i32 s[60:61], -8, v5
    s_nop 0
    v_cndmask_b32 v24, v4, 0, vcc
    v_cndmask_b32 v28, v4, 0, s[60:61]
    v_subrev_u32 v5, 1, v3
    v_cmp_gt_u32 vcc, 8, v5
    v_cmp_gt_i32 s[60:61], -8, v5
    s_nop 0
    v_cndmask_b32 v25, v4, 0, vcc
    v_cndmask_b32 v29, v4, 0, s[60:61]
    v_subrev_u32 v5, 2, v3
    v_cmp_gt_u32 vcc, 8, v5
    v_cmp_gt_i32 s[60:61], -8, v5
    s_nop 0
    v_cndmask_b32 v26, v4, 0, vcc
    v_cndmask_b32 v30, v4, 0, s[60:61]
    v_subrev_u32 v5, 3, v3
    v_cmp_gt_u32 vcc, 8, v5
    v_cmp_gt_i32 s[60:61], -8, v5
    s_nop 0
    v_cndmask_b32 v27, v4, 0, vcc
    v_cndmask_b32 v31, v4, 0, s[60:61]
    s_cmp_lt_u32 s54, 2
    s_cselect_b32 s58, s58, 0
    v_min_f32 v32, s58, v28
    v_min_f32 v33, s58, v29
    v_min_f32 v34, s58, v30
    v_min_f32 v35, s58, v31
    v_lshlrev_b32 v20, 2, v12
    v_add_u32 v20, 139264, v20
    v_lshlrev_b32 v21, 4, v13
    v_add_u32 v21, 139264, v21
    s_mov_b32 s59, 0x3eb8aa3b
    s_waitcnt lgkmcnt(0)
    s_mov_b32 s40, s22
    s_and_b32 s41, s23, 0xffff
    s_mov_b32 s42, 0x2000000
    s_mov_b32 s43, 0x20000
    s_mov_b32 s32, s20
    s_and_b32 s33, s21, 0xffff
    s_mov_b32 s34, 0x100
    s_mov_b32 s35, 0x20000
    s_or_b32 s48, s2, s44
    s_cmp_lg_u32 s48, 0
    s_cbranch_scc1 P1_NONON
    s_memrealtime s[90:91]
    s_waitcnt lgkmcnt(0)
    s_or_b32 s48, s90, 1
    v_mov_b32 v6, s48
    buffer_store_dword v6, v7, s[32:35], 0 offen sc1
P1_NONON:
    s_barrier
    ds_read_b64_tr_b16 v[168:169], v14 offset:0
    ds_read_b64_tr_b16 v[170:171], v14 offset:512
    ds_read_b128 v[148:151], v16 offset:0
    ds_read_b64_tr_b16 v[172:173], v14 offset:1024
    ds_read_b64_tr_b16 v[174:175], v14 offset:1536
    ds_read_b64_tr_b16 v[176:177], v14 offset:2048
    ds_read_b64_tr_b16 v[178:179], v14 offset:2560
    ds_read_b128 v[152:155], v16 offset:2048
    ds_read_b128 v[156:159], v16 offset:4096
    ds_read_b128 v[160:163], v16 offset:6144
    ds_read_b128 v[164:167], v16 offset:8192
    s_waitcnt lgkmcnt(0)
    v_mfma_f32_16x16x32_bf16 v[36:39], v[168:171], v[148:151], 0
    ds_read_b64_tr_b16 v[200:201], v14 offset:12288
    ds_read_b64_tr_b16 v[202:203], v14 offset:12800
    v_mfma_f32_16x16x32_bf16 v[56:59], v[172:175], v[148:151], 0
    ds_read_b128 v[180:183], v17 offset:0
    v_mfma_f32_16x16x32_bf16 v[76:79], v[148:151], v[176:179], 0
    ds_read_b64_tr_b16 v[204:205], v14 offset:13312
    ds_read_b64_tr_b16 v[206:207], v14 offset:13824
    v_mfma_f32_16x16x32_bf16 v[40:43], v[168:171], v[152:155], 0
    ds_read_b64_tr_b16 v[208:209], v14 offset:14336
    v_mfma_f32_16x16x32_bf16 v[60:63], v[172:175], v[152:155], 0
    ds_read_b64_tr_b16 v[210:211], v14 offset:14848
    v_mfma_f32_16x16x32_bf16 v[80:83], v[152:155], v[176:179], 0
    ds_read_b128 v[184:187], v17 offset:2048
    ds_read_b128 v[188:191], v17 offset:4096
    v_mfma_f32_16x16x32_bf16 v[44:47], v[168:171], v[156:159], 0
    ds_read_b128 v[192:195], v17 offset:6144
    v_mfma_f32_16x16x32_bf16 v[64:67], v[172:175], v[156:159], 0
    ds_read_b128 v[196:199], v17 offset:8192
    v_mfma_f32_16x16x32_bf16 v[84:87], v[156:159], v[176:179], 0
    v_mfma_f32_16x16x32_bf16 v[48:51], v[168:171], v[160:163], 0
    v_mfma_f32_16x16x32_bf16 v[68:71], v[172:175], v[160:163], 0
    v_mfma_f32_16x16x32_bf16 v[88:91], v[160:163], v[176:179], 0
    v_mfma_f32_16x16x32_bf16 v[52:55], v[168:171], v[164:167], 0
    v_mfma_f32_16x16x32_bf16 v[72:75], v[172:175], v[164:167], 0
    v_mfma_f32_16x16x32_bf16 v[92:95], v[164:167], v[176:179], 0
    s_waitcnt lgkmcnt(0)
    s_barrier
    v_mfma_f32_16x16x32_bf16 v[36:39], v[200:203], v[180:183], v[36:39]
    ds_read_b64_tr_b16 v[168:169], v14 offset:34816
    ds_read_b64_tr_b16 v[170:171], v14 offset:35328
    v_mfma_f32_16x16x32_bf16 v[56:59], v[204:207], v[180:183], v[56:59]
    ds_read_b128 v[148:151], v16 offset:34816
    v_mfma_f32_16x16x32_bf16 v[76:79], v[180:183], v[208:211], v[76:79]
    ds_read_b64_tr_b16 v[172:173], v14 offset:35840
    ds_read_b64_tr_b16 v[174:175], v14 offset:36352
    v_mfma_f32_16x16x32_bf16 v[40:43], v[200:203], v[184:187], v[40:43]
    ds_read_b64_tr_b16 v[176:177], v14 offset:36864
    v_mfma_f32_16x16x32_bf16 v[60:63], v[204:207], v[184:187], v[60:63]
    ds_read_b64_tr_b16 v[178:179], v14 offset:37376
    v_mfma_f32_16x16x32_bf16 v[80:83], v[184:187], v[208:211], v[80:83]
    ds_read_b128 v[152:155], v16 offset:36864
    ds_read_b128 v[156:159], v16 offset:38912
    v_mfma_f32_16x16x32_bf16 v[44:47], v[200:203], v[188:191], v[44:47]
    ds_read_b128 v[160:163], v16 offset:40960
    v_mfma_f32_16x16x32_bf16 v[64:67], v[204:207], v[188:191], v[64:67]
    ds_read_b128 v[164:167], v16 offset:43008
    v_mfma_f32_16x16x32_bf16 v[84:87], v[188:191], v[208:211], v[84:87]
    v_mfma_f32_16x16x32_bf16 v[48:51], v[200:203], v[192:195], v[48:51]
    v_mfma_f32_16x16x32_bf16 v[68:71], v[204:207], v[192:195], v[68:71]
    v_mfma_f32_16x16x32_bf16 v[88:91], v[192:195], v[208:211], v[88:91]
    v_mfma_f32_16x16x32_bf16 v[52:55], v[200:203], v[196:199], v[52:55]
    v_mfma_f32_16x16x32_bf16 v[72:75], v[204:207], v[196:199], v[72:75]
    v_mfma_f32_16x16x32_bf16 v[92:95], v[196:199], v[208:211], v[92:95]
    s_waitcnt lgkmcnt(0)
    v_mfma_f32_16x16x32_bf16 v[36:39], v[168:171], v[148:151], v[36:39]
    ds_read_b64_tr_b16 v[200:201], v14 offset:47104
    ds_read_b64_tr_b16 v[202:203], v14 offset:47616
    v_mfma_f32_16x16x32_bf16 v[56:59], v[172:175], v[148:151], v[56:59]
    ds_read_b128 v[180:183], v17 offset:34816
    v_mfma_f32_16x16x32_bf16 v[76:79], v[148:151], v[176:179], v[76:79]
    ds_read_b64_tr_b16 v[204:205], v14 offset:48128
    ds_read_b64_tr_b16 v[206:207], v14 offset:48640
    v_mfma_f32_16x16x32_bf16 v[40:43], v[168:171], v[152:155], v[40:43]
    ds_read_b64_tr_b16 v[208:209], v14 offset:49152
    v_mfma_f32_16x16x32_bf16 v[60:63], v[172:175], v[152:155], v[60:63]
    ds_read_b64_tr_b16 v[210:211], v14 offset:49664
    v_mfma_f32_16x16x32_bf16 v[80:83], v[152:155], v[176:179], v[80:83]
    ds_read_b128 v[184:187], v17 offset:36864
    ds_read_b128 v[188:191], v17 offset:38912
    v_mfma_f32_16x16x32_bf16 v[44:47], v[168:171], v[156:159], v[44:47]
    ds_read_b128 v[192:195], v17 offset:40960
    v_mfma_f32_16x16x32_bf16 v[64:67], v[172:175], v[156:159], v[64:67]
    ds_read_b128 v[196:199], v17 offset:43008
    v_mfma_f32_16x16x32_bf16 v[84:87], v[156:159], v[176:179], v[84:87]
    v_mfma_f32_16x16x32_bf16 v[48:51], v[168:171], v[160:163], v[48:51]
    v_mfma_f32_16x16x32_bf16 v[68:71], v[172:175], v[160:163], v[68:71]
    v_mfma_f32_16x16x32_bf16 v[88:91], v[160:163], v[176:179], v[88:91]
    v_mfma_f32_16x16x32_bf16 v[52:55], v[168:171], v[164:167], v[52:55]
    v_mfma_f32_16x16x32_bf16 v[72:75], v[172:175], v[164:167], v[72:75]
    v_mfma_f32_16x16x32_bf16 v[92:95], v[164:167], v[176:179], v[92:95]
    s_waitcnt lgkmcnt(0)
    s_barrier
    v_mfma_f32_16x16x32_bf16 v[36:39], v[200:203], v[180:183], v[36:39]
    ds_read_b64_tr_b16 v[168:169], v15 offset:0
    ds_read_b64_tr_b16 v[170:171], v15 offset:512
    v_mfma_f32_16x16x32_bf16 v[56:59], v[204:207], v[180:183], v[56:59]
    ds_read_b128 v[148:151], v18 offset:0
    v_mfma_f32_16x16x32_bf16 v[76:79], v[180:183], v[208:211], v[76:79]
    ds_read_b64_tr_b16 v[172:173], v15 offset:1024
    ds_read_b64_tr_b16 v[174:175], v15 offset:1536
    v_mfma_f32_16x16x32_bf16 v[40:43], v[200:203], v[184:187], v[40:43]
    ds_read_b64_tr_b16 v[176:177], v15 offset:2048
    v_mfma_f32_16x16x32_bf16 v[60:63], v[204:207], v[184:187], v[60:63]
    ds_read_b64_tr_b16 v[178:179], v15 offset:2560
    v_mfma_f32_16x16x32_bf16 v[80:83], v[184:187], v[208:211], v[80:83]
    ds_read_b128 v[152:155], v18 offset:2048
    ds_read_b128 v[156:159], v18 offset:4096
    v_mfma_f32_16x16x32_bf16 v[44:47], v[200:203], v[188:191], v[44:47]
    ds_read_b128 v[160:163], v18 offset:6144
    v_mfma_f32_16x16x32_bf16 v[64:67], v[204:207], v[188:191], v[64:67]
    ds_read_b128 v[164:167], v18 offset:8192
    v_mfma_f32_16x16x32_bf16 v[84:87], v[188:191], v[208:211], v[84:87]
    v_mfma_f32_16x16x32_bf16 v[48:51], v[200:203], v[192:195], v[48:51]
    v_mfma_f32_16x16x32_bf16 v[68:71], v[204:207], v[192:195], v[68:71]
    v_mfma_f32_16x16x32_bf16 v[88:91], v[192:195], v[208:211], v[88:91]
    v_mfma_f32_16x16x32_bf16 v[52:55], v[200:203], v[196:199], v[52:55]
    v_mfma_f32_16x16x32_bf16 v[72:75], v[204:207], v[196:199], v[72:75]
    v_mfma_f32_16x16x32_bf16 v[92:95], v[196:199], v[208:211], v[92:95]
    s_waitcnt lgkmcnt(0)
    v_mfma_f32_16x16x32_bf16 v[36:39], v[168:171], v[148:151], v[36:39]
    ds_read_b64_tr_b16 v[200:201], v15 offset:12288
    ds_read_b64_tr_b16 v[202:203], v15 offset:12800
    v_mfma_f32_16x16x32_bf16 v[56:59], v[172:175], v[148:151], v[56:59]
    ds_read_b128 v[180:183], v19 offset:0
    v_mfma_f32_16x16x32_bf16 v[76:79], v[148:151], v[176:179], v[76:79]
    ds_read_b64_tr_b16 v[204:205], v15 offset:13312
    ds_read_b64_tr_b16 v[206:207], v15 offset:13824
    v_mfma_f32_16x16x32_bf16 v[40:43], v[168:171], v[152:155], v[40:43]
    ds_read_b64_tr_b16 v[208:209], v15 offset:14336
    v_mfma_f32_16x16x32_bf16 v[60:63], v[172:175], v[152:155], v[60:63]
    ds_read_b64_tr_b16 v[210:211], v15 offset:14848
    v_mfma_f32_16x16x32_bf16 v[80:83], v[152:155], v[176:179], v[80:83]
    ds_read_b128 v[184:187], v19 offset:2048
    ds_read_b128 v[188:191], v19 offset:4096
    v_mfma_f32_16x16x32_bf16 v[44:47], v[168:171], v[156:159], v[44:47]
    ds_read_b128 v[192:195], v19 offset:6144
    v_mfma_f32_16x16x32_bf16 v[64:67], v[172:175], v[156:159], v[64:67]
    ds_read_b128 v[196:199], v19 offset:8192
    v_mfma_f32_16x16x32_bf16 v[84:87], v[156:159], v[176:179], v[84:87]
    v_mfma_f32_16x16x32_bf16 v[48:51], v[168:171], v[160:163], v[48:51]
    v_mfma_f32_16x16x32_bf16 v[68:71], v[172:175], v[160:163], v[68:71]
    v_mfma_f32_16x16x32_bf16 v[88:91], v[160:163], v[176:179], v[88:91]
    v_mfma_f32_16x16x32_bf16 v[52:55], v[168:171], v[164:167], v[52:55]
    v_mfma_f32_16x16x32_bf16 v[72:75], v[172:175], v[164:167], v[72:75]
    v_mfma_f32_16x16x32_bf16 v[92:95], v[164:167], v[176:179], v[92:95]
    s_waitcnt lgkmcnt(0)
    s_barrier
    v_mfma_f32_16x16x32_bf16 v[36:39], v[200:203], v[180:183], v[36:39]
    ds_read_b64_tr_b16 v[168:169], v15 offset:34816
    ds_read_b64_tr_b16 v[170:171], v15 offset:35328
    v_mfma_f32_16x16x32_bf16 v[56:59], v[204:207], v[180:183], v[56:59]
    ds_read_b128 v[148:151], v18 offset:34816
    v_mfma_f32_16x16x32_bf16 v[76:79], v[180:183], v[208:211], v[76:79]
    ds_read_b64_tr_b16 v[172:173], v15 offset:35840
    ds_read_b64_tr_b16 v[174:175], v15 offset:36352
    v_mfma_f32_16x16x32_bf16 v[40:43], v[200:203], v[184:187], v[40:43]
    ds_read_b64_tr_b16 v[176:177], v15 offset:36864
    v_mfma_f32_16x16x32_bf16 v[60:63], v[204:207], v[184:187], v[60:63]
    ds_read_b64_tr_b16 v[178:179], v15 offset:37376
    v_mfma_f32_16x16x32_bf16 v[80:83], v[184:187], v[208:211], v[80:83]
    ds_read_b128 v[152:155], v18 offset:36864
    ds_read_b128 v[156:159], v18 offset:38912
    v_mfma_f32_16x16x32_bf16 v[44:47], v[200:203], v[188:191], v[44:47]
    ds_read_b128 v[160:163], v18 offset:40960
    v_mfma_f32_16x16x32_bf16 v[64:67], v[204:207], v[188:191], v[64:67]
    ds_read_b128 v[164:167], v18 offset:43008
    v_mfma_f32_16x16x32_bf16 v[84:87], v[188:191], v[208:211], v[84:87]
    v_mfma_f32_16x16x32_bf16 v[48:51], v[200:203], v[192:195], v[48:51]
    v_mfma_f32_16x16x32_bf16 v[68:71], v[204:207], v[192:195], v[68:71]
    v_mfma_f32_16x16x32_bf16 v[88:91], v[192:195], v[208:211], v[88:91]
    v_mfma_f32_16x16x32_bf16 v[52:55], v[200:203], v[196:199], v[52:55]
    v_mfma_f32_16x16x32_bf16 v[72:75], v[204:207], v[196:199], v[72:75]
    v_mfma_f32_16x16x32_bf16 v[92:95], v[196:199], v[208:211], v[92:95]
    s_waitcnt lgkmcnt(0)
    v_mfma_f32_16x16x32_bf16 v[36:39], v[168:171], v[148:151], v[36:39]
    ds_read_b64_tr_b16 v[200:201], v15 offset:47104
    ds_read_b64_tr_b16 v[202:203], v15 offset:47616
    v_mfma_f32_16x16x32_bf16 v[56:59], v[172:175], v[148:151], v[56:59]
    ds_read_b128 v[180:183], v19 offset:34816
    v_mfma_f32_16x16x32_bf16 v[76:79], v[148:151], v[176:179], v[76:79]
    ds_read_b64_tr_b16 v[204:205], v15 offset:48128
    ds_read_b64_tr_b16 v[206:207], v15 offset:48640
    v_mfma_f32_16x16x32_bf16 v[40:43], v[168:171], v[152:155], v[40:43]
    ds_read_b64_tr_b16 v[208:209], v15 offset:49152
    v_mfma_f32_16x16x32_bf16 v[60:63], v[172:175], v[152:155], v[60:63]
    ds_read_b64_tr_b16 v[210:211], v15 offset:49664
    v_mfma_f32_16x16x32_bf16 v[80:83], v[152:155], v[176:179], v[80:83]
    ds_read_b128 v[184:187], v19 offset:36864
    ds_read_b128 v[188:191], v19 offset:38912
    v_mfma_f32_16x16x32_bf16 v[44:47], v[168:171], v[156:159], v[44:47]
    ds_read_b128 v[192:195], v19 offset:40960
    v_mfma_f32_16x16x32_bf16 v[64:67], v[172:175], v[156:159], v[64:67]
    ds_read_b128 v[196:199], v19 offset:43008
    v_mfma_f32_16x16x32_bf16 v[84:87], v[156:159], v[176:179], v[84:87]
    v_mfma_f32_16x16x32_bf16 v[48:51], v[168:171], v[160:163], v[48:51]
    v_mfma_f32_16x16x32_bf16 v[68:71], v[172:175], v[160:163], v[68:71]
    v_mfma_f32_16x16x32_bf16 v[88:91], v[160:163], v[176:179], v[88:91]
    v_mfma_f32_16x16x32_bf16 v[52:55], v[168:171], v[164:167], v[52:55]
    v_mfma_f32_16x16x32_bf16 v[72:75], v[172:175], v[164:167], v[72:75]
    v_mfma_f32_16x16x32_bf16 v[92:95], v[164:167], v[176:179], v[92:95]
    s_waitcnt lgkmcnt(0)
    s_barrier
    v_mfma_f32_16x16x32_bf16 v[36:39], v[200:203], v[180:183], v[36:39]
    ds_read_b64_tr_b16 v[168:169], v14 offset:0
    ds_read_b64_tr_b16 v[170:171], v14 offset:512
    v_mfma_f32_16x16x32_bf16 v[56:59], v[204:207], v[180:183], v[56:59]
    ds_read_b128 v[148:151], v16 offset:0
    v_mfma_f32_16x16x32_bf16 v[76:79], v[180:183], v[208:211], v[76:79]
    ds_read_b64_tr_b16 v[172:173], v14 offset:1024
    ds_read_b64_tr_b16 v[174:175], v14 offset:1536
    v_mfma_f32_16x16x32_bf16 v[40:43], v[200:203], v[184:187], v[40:43]
    ds_read_b64_tr_b16 v[176:177], v14 offset:2048
    v_mfma_f32_16x16x32_bf16 v[60:63], v[204:207], v[184:187], v[60:63]
    ds_read_b64_tr_b16 v[178:179], v14 offset:2560
    v_mfma_f32_16x16x32_bf16 v[80:83], v[184:187], v[208:211], v[80:83]
    ds_read_b128 v[152:155], v16 offset:2048
    ds_read_b128 v[156:159], v16 offset:4096
    v_mfma_f32_16x16x32_bf16 v[44:47], v[200:203], v[188:191], v[44:47]
    ds_read_b128 v[160:163], v16 offset:6144
    v_mfma_f32_16x16x32_bf16 v[64:67], v[204:207], v[188:191], v[64:67]
    ds_read_b128 v[164:167], v16 offset:8192
    v_mfma_f32_16x16x32_bf16 v[84:87], v[188:191], v[208:211], v[84:87]
    v_mfma_f32_16x16x32_bf16 v[48:51], v[200:203], v[192:195], v[48:51]
    v_mfma_f32_16x16x32_bf16 v[68:71], v[204:207], v[192:195], v[68:71]
    v_mfma_f32_16x16x32_bf16 v[88:91], v[192:195], v[208:211], v[88:91]
    v_mfma_f32_16x16x32_bf16 v[52:55], v[200:203], v[196:199], v[52:55]
    v_mfma_f32_16x16x32_bf16 v[72:75], v[204:207], v[196:199], v[72:75]
    v_mfma_f32_16x16x32_bf16 v[92:95], v[196:199], v[208:211], v[92:95]
    s_waitcnt lgkmcnt(0)
    v_mfma_f32_16x16x32_bf16 v[36:39], v[168:171], v[148:151], v[36:39]
    ds_read_b64_tr_b16 v[200:201], v14 offset:12288
    ds_read_b64_tr_b16 v[202:203], v14 offset:12800
    v_mfma_f32_16x16x32_bf16 v[56:59], v[172:175], v[148:151], v[56:59]
    ds_read_b128 v[180:183], v17 offset:0
    v_mfma_f32_16x16x32_bf16 v[76:79], v[148:151], v[176:179], v[76:79]
    ds_read_b64_tr_b16 v[204:205], v14 offset:13312
    ds_read_b64_tr_b16 v[206:207], v14 offset:13824
    v_mfma_f32_16x16x32_bf16 v[40:43], v[168:171], v[152:155], v[40:43]
    ds_read_b64_tr_b16 v[208:209], v14 offset:14336
    v_mfma_f32_16x16x32_bf16 v[60:63], v[172:175], v[152:155], v[60:63]
    ds_read_b64_tr_b16 v[210:211], v14 offset:14848
    v_mfma_f32_16x16x32_bf16 v[80:83], v[152:155], v[176:179], v[80:83]
    ds_read_b128 v[184:187], v17 offset:2048
    ds_read_b128 v[188:191], v17 offset:4096
    v_mfma_f32_16x16x32_bf16 v[44:47], v[168:171], v[156:159], v[44:47]
    ds_read_b128 v[192:195], v17 offset:6144
    v_mfma_f32_16x16x32_bf16 v[64:67], v[172:175], v[156:159], v[64:67]
    ds_read_b128 v[196:199], v17 offset:8192
    v_mfma_f32_16x16x32_bf16 v[84:87], v[156:159], v[176:179], v[84:87]
    v_mfma_f32_16x16x32_bf16 v[48:51], v[168:171], v[160:163], v[48:51]
    v_mfma_f32_16x16x32_bf16 v[68:71], v[172:175], v[160:163], v[68:71]
    v_mfma_f32_16x16x32_bf16 v[88:91], v[160:163], v[176:179], v[88:91]
    v_mfma_f32_16x16x32_bf16 v[52:55], v[168:171], v[164:167], v[52:55]
    v_mfma_f32_16x16x32_bf16 v[72:75], v[172:175], v[164:167], v[72:75]
    v_mfma_f32_16x16x32_bf16 v[92:95], v[164:167], v[176:179], v[92:95]
    s_waitcnt lgkmcnt(0)
    s_barrier
    v_mfma_f32_16x16x32_bf16 v[36:39], v[200:203], v[180:183], v[36:39]
    ds_read_b64_tr_b16 v[168:169], v14 offset:34816
    ds_read_b64_tr_b16 v[170:171], v14 offset:35328
    v_mfma_f32_16x16x32_bf16 v[56:59], v[204:207], v[180:183], v[56:59]
    ds_read_b128 v[148:151], v16 offset:34816
    v_mfma_f32_16x16x32_bf16 v[76:79], v[180:183], v[208:211], v[76:79]
    ds_read_b64_tr_b16 v[172:173], v14 offset:35840
    ds_read_b64_tr_b16 v[174:175], v14 offset:36352
    v_mfma_f32_16x16x32_bf16 v[40:43], v[200:203], v[184:187], v[40:43]
    ds_read_b64_tr_b16 v[176:177], v14 offset:36864
    v_mfma_f32_16x16x32_bf16 v[60:63], v[204:207], v[184:187], v[60:63]
    ds_read_b64_tr_b16 v[178:179], v14 offset:37376
    v_mfma_f32_16x16x32_bf16 v[80:83], v[184:187], v[208:211], v[80:83]
    ds_read_b128 v[152:155], v16 offset:36864
    ds_read_b128 v[156:159], v16 offset:38912
    v_mfma_f32_16x16x32_bf16 v[44:47], v[200:203], v[188:191], v[44:47]
    ds_read_b128 v[160:163], v16 offset:40960
    v_mfma_f32_16x16x32_bf16 v[64:67], v[204:207], v[188:191], v[64:67]
    ds_read_b128 v[164:167], v16 offset:43008
    v_mfma_f32_16x16x32_bf16 v[84:87], v[188:191], v[208:211], v[84:87]
    v_mfma_f32_16x16x32_bf16 v[48:51], v[200:203], v[192:195], v[48:51]
    v_mfma_f32_16x16x32_bf16 v[68:71], v[204:207], v[192:195], v[68:71]
    v_mfma_f32_16x16x32_bf16 v[88:91], v[192:195], v[208:211], v[88:91]
    v_mfma_f32_16x16x32_bf16 v[52:55], v[200:203], v[196:199], v[52:55]
    v_mfma_f32_16x16x32_bf16 v[72:75], v[204:207], v[196:199], v[72:75]
    v_mfma_f32_16x16x32_bf16 v[92:95], v[196:199], v[208:211], v[92:95]
    s_waitcnt lgkmcnt(0)
    v_mfma_f32_16x16x32_bf16 v[36:39], v[168:171], v[148:151], v[36:39]
    ds_read_b64_tr_b16 v[200:201], v14 offset:47104
    ds_read_b64_tr_b16 v[202:203], v14 offset:47616
    v_mfma_f32_16x16x32_bf16 v[56:59], v[172:175], v[148:151], v[56:59]
    ds_read_b128 v[180:183], v17 offset:34816
    v_mfma_f32_16x16x32_bf16 v[76:79], v[148:151], v[176:179], v[76:79]
    ds_read_b64_tr_b16 v[204:205], v14 offset:48128
    ds_read_b64_tr_b16 v[206:207], v14 offset:48640
    v_mfma_f32_16x16x32_bf16 v[40:43], v[168:171], v[152:155], v[40:43]
    ds_read_b64_tr_b16 v[208:209], v14 offset:49152
    v_mfma_f32_16x16x32_bf16 v[60:63], v[172:175], v[152:155], v[60:63]
    ds_read_b64_tr_b16 v[210:211], v14 offset:49664
    v_mfma_f32_16x16x32_bf16 v[80:83], v[152:155], v[176:179], v[80:83]
    ds_read_b128 v[184:187], v17 offset:36864
    ds_read_b128 v[188:191], v17 offset:38912
    v_mfma_f32_16x16x32_bf16 v[44:47], v[168:171], v[156:159], v[44:47]
    ds_read_b128 v[192:195], v17 offset:40960
    v_mfma_f32_16x16x32_bf16 v[64:67], v[172:175], v[156:159], v[64:67]
    ds_read_b128 v[196:199], v17 offset:43008
    v_mfma_f32_16x16x32_bf16 v[84:87], v[156:159], v[176:179], v[84:87]
    v_mfma_f32_16x16x32_bf16 v[48:51], v[168:171], v[160:163], v[48:51]
    v_mfma_f32_16x16x32_bf16 v[68:71], v[172:175], v[160:163], v[68:71]
    v_mfma_f32_16x16x32_bf16 v[88:91], v[160:163], v[176:179], v[88:91]
    v_mfma_f32_16x16x32_bf16 v[52:55], v[168:171], v[164:167], v[52:55]
    v_mfma_f32_16x16x32_bf16 v[72:75], v[172:175], v[164:167], v[72:75]
    v_mfma_f32_16x16x32_bf16 v[92:95], v[164:167], v[176:179], v[92:95]
    s_waitcnt lgkmcnt(0)
    s_barrier
    v_mfma_f32_16x16x32_bf16 v[36:39], v[200:203], v[180:183], v[36:39]
    ds_read_b64_tr_b16 v[168:169], v15 offset:0
    ds_read_b64_tr_b16 v[170:171], v15 offset:512
    v_mfma_f32_16x16x32_bf16 v[56:59], v[204:207], v[180:183], v[56:59]
    ds_read_b128 v[148:151], v18 offset:0
    v_mfma_f32_16x16x32_bf16 v[76:79], v[180:183], v[208:211], v[76:79]
    ds_read_b64_tr_b16 v[172:173], v15 offset:1024
    ds_read_b64_tr_b16 v[174:175], v15 offset:1536
    v_mfma_f32_16x16x32_bf16 v[40:43], v[200:203], v[184:187], v[40:43]
    ds_read_b64_tr_b16 v[176:177], v15 offset:2048
    v_mfma_f32_16x16x32_bf16 v[60:63], v[204:207], v[184:187], v[60:63]
    ds_read_b64_tr_b16 v[178:179], v15 offset:2560
    v_mfma_f32_16x16x32_bf16 v[80:83], v[184:187], v[208:211], v[80:83]
    ds_read_b128 v[152:155], v18 offset:2048
    ds_read_b128 v[156:159], v18 offset:4096
    v_mfma_f32_16x16x32_bf16 v[44:47], v[200:203], v[188:191], v[44:47]
    ds_read_b128 v[160:163], v18 offset:6144
    v_mfma_f32_16x16x32_bf16 v[64:67], v[204:207], v[188:191], v[64:67]
    ds_read_b128 v[164:167], v18 offset:8192
    v_mfma_f32_16x16x32_bf16 v[84:87], v[188:191], v[208:211], v[84:87]
    v_mfma_f32_16x16x32_bf16 v[48:51], v[200:203], v[192:195], v[48:51]
    v_mfma_f32_16x16x32_bf16 v[68:71], v[204:207], v[192:195], v[68:71]
    v_mfma_f32_16x16x32_bf16 v[88:91], v[192:195], v[208:211], v[88:91]
    v_mfma_f32_16x16x32_bf16 v[52:55], v[200:203], v[196:199], v[52:55]
    v_mfma_f32_16x16x32_bf16 v[72:75], v[204:207], v[196:199], v[72:75]
    v_mfma_f32_16x16x32_bf16 v[92:95], v[196:199], v[208:211], v[92:95]
    s_waitcnt lgkmcnt(0)
    v_mfma_f32_16x16x32_bf16 v[36:39], v[168:171], v[148:151], v[36:39]
    ds_read_b64_tr_b16 v[200:201], v15 offset:12288
    ds_read_b64_tr_b16 v[202:203], v15 offset:12800
    v_mfma_f32_16x16x32_bf16 v[56:59], v[172:175], v[148:151], v[56:59]
    ds_read_b128 v[180:183], v19 offset:0
    v_mfma_f32_16x16x32_bf16 v[76:79], v[148:151], v[176:179], v[76:79]
    ds_read_b64_tr_b16 v[204:205], v15 offset:13312
    ds_read_b64_tr_b16 v[206:207], v15 offset:13824
    v_mfma_f32_16x16x32_bf16 v[40:43], v[168:171], v[152:155], v[40:43]
    ds_read_b64_tr_b16 v[208:209], v15 offset:14336
    v_mfma_f32_16x16x32_bf16 v[60:63], v[172:175], v[152:155], v[60:63]
    ds_read_b64_tr_b16 v[210:211], v15 offset:14848
    v_mfma_f32_16x16x32_bf16 v[80:83], v[152:155], v[176:179], v[80:83]
    ds_read_b128 v[184:187], v19 offset:2048
    ds_read_b128 v[188:191], v19 offset:4096
    v_mfma_f32_16x16x32_bf16 v[44:47], v[168:171], v[156:159], v[44:47]
    ds_read_b128 v[192:195], v19 offset:6144
    v_mfma_f32_16x16x32_bf16 v[64:67], v[172:175], v[156:159], v[64:67]
    ds_read_b128 v[196:199], v19 offset:8192
    v_mfma_f32_16x16x32_bf16 v[84:87], v[156:159], v[176:179], v[84:87]
    v_mfma_f32_16x16x32_bf16 v[48:51], v[168:171], v[160:163], v[48:51]
    v_mfma_f32_16x16x32_bf16 v[68:71], v[172:175], v[160:163], v[68:71]
    v_mfma_f32_16x16x32_bf16 v[88:91], v[160:163], v[176:179], v[88:91]
    v_mfma_f32_16x16x32_bf16 v[52:55], v[168:171], v[164:167], v[52:55]
    v_mfma_f32_16x16x32_bf16 v[72:75], v[172:175], v[164:167], v[72:75]
    v_mfma_f32_16x16x32_bf16 v[92:95], v[164:167], v[176:179], v[92:95]
    s_waitcnt lgkmcnt(0)
    s_barrier
    v_mfma_f32_16x16x32_bf16 v[36:39], v[200:203], v[180:183], v[36:39]
    ds_read_b64_tr_b16 v[168:169], v15 offset:34816
    ds_read_b64_tr_b16 v[170:171], v15 offset:35328
    v_mfma_f32_16x16x32_bf16 v[56:59], v[204:207], v[180:183], v[56:59]
    ds_read_b128 v[148:151], v18 offset:34816
    v_mfma_f32_16x16x32_bf16 v[76:79], v[180:183], v[208:211], v[76:79]
    ds_read_b64_tr_b16 v[172:173], v15 offset:35840
    ds_read_b64_tr_b16 v[174:175], v15 offset:36352
    v_mfma_f32_16x16x32_bf16 v[40:43], v[200:203], v[184:187], v[40:43]
    ds_read_b64_tr_b16 v[176:177], v15 offset:36864
    v_mfma_f32_16x16x32_bf16 v[60:63], v[204:207], v[184:187], v[60:63]
    ds_read_b64_tr_b16 v[178:179], v15 offset:37376
    v_mfma_f32_16x16x32_bf16 v[80:83], v[184:187], v[208:211], v[80:83]
    ds_read_b128 v[152:155], v18 offset:36864
    ds_read_b128 v[156:159], v18 offset:38912
    v_mfma_f32_16x16x32_bf16 v[44:47], v[200:203], v[188:191], v[44:47]
    ds_read_b128 v[160:163], v18 offset:40960
    v_mfma_f32_16x16x32_bf16 v[64:67], v[204:207], v[188:191], v[64:67]
    ds_read_b128 v[164:167], v18 offset:43008
    v_mfma_f32_16x16x32_bf16 v[84:87], v[188:191], v[208:211], v[84:87]
    v_mfma_f32_16x16x32_bf16 v[48:51], v[200:203], v[192:195], v[48:51]
    v_mfma_f32_16x16x32_bf16 v[68:71], v[204:207], v[192:195], v[68:71]
    v_mfma_f32_16x16x32_bf16 v[88:91], v[192:195], v[208:211], v[88:91]
    v_mfma_f32_16x16x32_bf16 v[52:55], v[200:203], v[196:199], v[52:55]
    v_mfma_f32_16x16x32_bf16 v[72:75], v[204:207], v[196:199], v[72:75]
    v_mfma_f32_16x16x32_bf16 v[92:95], v[196:199], v[208:211], v[92:95]
    s_waitcnt lgkmcnt(0)
    v_mfma_f32_16x16x32_bf16 v[36:39], v[168:171], v[148:151], v[36:39]
    ds_read_b64_tr_b16 v[200:201], v15 offset:47104
    ds_read_b64_tr_b16 v[202:203], v15 offset:47616
    v_mfma_f32_16x16x32_bf16 v[56:59], v[172:175], v[148:151], v[56:59]
    ds_read_b128 v[180:183], v19 offset:34816
    v_mfma_f32_16x16x32_bf16 v[76:79], v[148:151], v[176:179], v[76:79]
    ds_read_b64_tr_b16 v[204:205], v15 offset:48128
    ds_read_b64_tr_b16 v[206:207], v15 offset:48640
    v_mfma_f32_16x16x32_bf16 v[40:43], v[168:171], v[152:155], v[40:43]
    ds_read_b64_tr_b16 v[208:209], v15 offset:49152
    v_mfma_f32_16x16x32_bf16 v[60:63], v[172:175], v[152:155], v[60:63]
    ds_read_b64_tr_b16 v[210:211], v15 offset:49664
    v_mfma_f32_16x16x32_bf16 v[80:83], v[152:155], v[176:179], v[80:83]
    ds_read_b128 v[184:187], v19 offset:36864
    ds_read_b128 v[188:191], v19 offset:38912
    v_mfma_f32_16x16x32_bf16 v[44:47], v[168:171], v[156:159], v[44:47]
    ds_read_b128 v[192:195], v19 offset:40960
    v_mfma_f32_16x16x32_bf16 v[64:67], v[172:175], v[156:159], v[64:67]
    ds_read_b128 v[196:199], v19 offset:43008
    v_mfma_f32_16x16x32_bf16 v[84:87], v[156:159], v[176:179], v[84:87]
    v_mfma_f32_16x16x32_bf16 v[48:51], v[168:171], v[160:163], v[48:51]
    v_mfma_f32_16x16x32_bf16 v[68:71], v[172:175], v[160:163], v[68:71]
    v_mfma_f32_16x16x32_bf16 v[88:91], v[160:163], v[176:179], v[88:91]
    v_mfma_f32_16x16x32_bf16 v[52:55], v[168:171], v[164:167], v[52:55]
    v_mfma_f32_16x16x32_bf16 v[72:75], v[172:175], v[164:167], v[72:75]
    v_mfma_f32_16x16x32_bf16 v[92:95], v[164:167], v[176:179], v[92:95]
    s_waitcnt lgkmcnt(0)
    v_mfma_f32_16x16x32_bf16 v[36:39], v[200:203], v[180:183], v[36:39]
    v_mfma_f32_16x16x32_bf16 v[56:59], v[204:207], v[180:183], v[56:59]
    v_mfma_f32_16x16x32_bf16 v[76:79], v[180:183], v[208:211], v[76:79]
    v_mfma_f32_16x16x32_bf16 v[40:43], v[200:203], v[184:187], v[40:43]
    v_mfma_f32_16x16x32_bf16 v[60:63], v[204:207], v[184:187], v[60:63]
    v_mfma_f32_16x16x32_bf16 v[80:83], v[184:187], v[208:211], v[80:83]
    v_mfma_f32_16x16x32_bf16 v[44:47], v[200:203], v[188:191], v[44:47]
    s_nop 1
    v_mov_b32_dpp v148, v36 row_newbcast:0 row_mask:0xf bank_mask:0xf
    v_mov_b32_dpp v149, v37 row_newbcast:0 row_mask:0xf bank_mask:0xf
    v_mfma_f32_16x16x32_bf16 v[64:67], v[204:207], v[188:191], v[64:67]
    v_mov_b32_dpp v150, v38 row_newbcast:0 row_mask:0xf bank_mask:0xf
    v_mfma_f32_16x16x32_bf16 v[84:87], v[188:191], v[208:211], v[84:87]
    v_mov_b32_dpp v151, v39 row_newbcast:0 row_mask:0xf bank_mask:0xf
    v_mfma_f32_16x16x32_bf16 v[48:51], v[200:203], v[192:195], v[48:51]
    v_mov_b32_dpp v152, v56 row_newbcast:0 row_mask:0xf bank_mask:0xf
    v_mfma_f32_16x16x32_bf16 v[68:71], v[204:207], v[192:195], v[68:71]
    v_mov_b32_dpp v153, v57 row_newbcast:0 row_mask:0xf bank_mask:0xf
    v_mfma_f32_16x16x32_bf16 v[88:91], v[192:195], v[208:211], v[88:91]
    v_mov_b32_dpp v154, v58 row_newbcast:0 row_mask:0xf bank_mask:0xf
    v_mfma_f32_16x16x32_bf16 v[52:55], v[200:203], v[196:199], v[52:55]
    v_mov_b32_dpp v155, v59 row_newbcast:0 row_mask:0xf bank_mask:0xf
    v_mfma_f32_16x16x32_bf16 v[72:75], v[204:207], v[196:199], v[72:75]
    v_mov_b32 v156, v76
    v_mfma_f32_16x16x32_bf16 v[92:95], v[196:199], v[208:211], v[92:95]
    v_mov_b32 v157, v76
LW_1:
    ds_read_b32 v5, v11 offset:36
    ds_read2_b32 v[96:97], v20 offset0:0 offset1:80
    ds_read2_b32 v[98:99], v20 offset0:16 offset1:96
    ds_read2_b32 v[100:101], v20 offset0:32 offset1:112
    ds_read2_b32 v[102:103], v20 offset0:48 offset1:128
    ds_read2_b32 v[104:105], v20 offset0:64 offset1:144
    ds_read_b128 v[108:111], v21 offset:0
    ds_read_b128 v[128:131], v21 offset:320
    ds_read_b128 v[112:115], v21 offset:64
    ds_read_b128 v[132:135], v21 offset:384
    ds_read_b128 v[116:119], v21 offset:128
    ds_read_b128 v[136:139], v21 offset:448
    ds_read_b128 v[120:123], v21 offset:192
    ds_read_b128 v[140:143], v21 offset:512
    ds_read_b128 v[124:127], v21 offset:256
    s_waitcnt lgkmcnt(14)
    v_readfirstlane_b32 s48, v5
    s_nop 0
    s_cmp_lt_u32 s48, 3
    s_cbranch_scc1 LW_1
    ds_read_b128 v[144:147], v21 offset:576
    s_waitcnt lgkmcnt(0)
    v_permlane32_swap_b32 v156, v157
    v_mul_f32 v158, s59, v99
    v_mul_f32 v160, s59, v101
    v_mul_f32 v162, s59, v103
    v_mul_f32 v164, s59, v105
    v_pk_fma_f32 v[56:57], v[152:153], v[96:97], v[56:57] op_sel:[0,0,0] op_sel_hi:[1,0,1] neg_lo:[0,1,0] neg_hi:[0,1,0]
    v_pk_fma_f32 v[58:59], v[154:155], v[96:97], v[58:59] op_sel:[0,0,0] op_sel_hi:[1,0,1] neg_lo:[0,1,0] neg_hi:[0,1,0]
    v_pk_fma_f32 v[60:61], v[152:153], v[98:99], v[60:61] op_sel:[0,0,0] op_sel_hi:[1,0,1] neg_lo:[0,1,0] neg_hi:[0,1,0]
    v_pk_fma_f32 v[62:63], v[154:155], v[98:99], v[62:63] op_sel:[0,0,0] op_sel_hi:[1,0,1] neg_lo:[0,1,0] neg_hi:[0,1,0]
    v_pk_fma_f32 v[40:41], v[148:149], v[98:99], v[40:41] op_sel:[0,0,0] op_sel_hi:[1,0,1] neg_lo:[0,1,0] neg_hi:[0,1,0]
    v_pk_fma_f32 v[42:43], v[150:151], v[98:99], v[42:43] op_sel:[0,0,0] op_sel_hi:[1,0,1] neg_lo:[0,1,0] neg_hi:[0,1,0]
    v_pk_fma_f32 v[64:65], v[152:153], v[100:101], v[64:65] op_sel:[0,0,0] op_sel_hi:[1,0,1] neg_lo:[0,1,0] neg_hi:[0,1,0]
    v_pk_fma_f32 v[66:67], v[154:155], v[100:101], v[66:67] op_sel:[0,0,0] op_sel_hi:[1,0,1] neg_lo:[0,1,0] neg_hi:[0,1,0]
    v_pk_fma_f32 v[44:45], v[148:149], v[100:101], v[44:45] op_sel:[0,0,0] op_sel_hi:[1,0,1] neg_lo:[0,1,0] neg_hi:[0,1,0]
    v_pk_fma_f32 v[46:47], v[150:151], v[100:101], v[46:47] op_sel:[0,0,0] op_sel_hi:[1,0,1] neg_lo:[0,1,0] neg_hi:[0,1,0]
    v_pk_fma_f32 v[68:69], v[152:153], v[102:103], v[68:69] op_sel:[0,0,0] op_sel_hi:[1,0,1] neg_lo:[0,1,0] neg_hi:[0,1,0]
    v_pk_fma_f32 v[70:71], v[154:155], v[102:103], v[70:71] op_sel:[0,0,0] op_sel_hi:[1,0,1] neg_lo:[0,1,0] neg_hi:[0,1,0]
    v_pk_fma_f32 v[48:49], v[148:149], v[102:103], v[48:49] op_sel:[0,0,0] op_sel_hi:[1,0,1] neg_lo:[0,1,0] neg_hi:[0,1,0]
    v_pk_fma_f32 v[50:51], v[150:151], v[102:103], v[50:51] op_sel:[0,0,0] op_sel_hi:[1,0,1] neg_lo:[0,1,0] neg_hi:[0,1,0]
    v_pk_fma_f32 v[72:73], v[152:153], v[104:105], v[72:73] op_sel:[0,0,0] op_sel_hi:[1,0,1] neg_lo:[0,1,0] neg_hi:[0,1,0]
    v_pk_fma_f32 v[74:75], v[154:155], v[104:105], v[74:75] op_sel:[0,0,0] op_sel_hi:[1,0,1] neg_lo:[0,1,0] neg_hi:[0,1,0]
    v_pk_fma_f32 v[52:53], v[148:149], v[104:105], v[52:53] op_sel:[0,0,0] op_sel_hi:[1,0,1] neg_lo:[0,1,0] neg_hi:[0,1,0]
    v_pk_fma_f32 v[54:55], v[150:151], v[104:105], v[54:55] op_sel:[0,0,0] op_sel_hi:[1,0,1] neg_lo:[0,1,0] neg_hi:[0,1,0]
    v_pk_mul_f32 v[56:57], v[56:57], v[96:97] op_sel:[0,1] op_sel_hi:[1,1]
    v_pk_mul_f32 v[58:59], v[58:59], v[96:97] op_sel:[0,1] op_sel_hi:[1,1]
    v_pk_mul_f32 v[60:61], v[60:61], v[98:99] op_sel:[0,1] op_sel_hi:[1,1]
    v_pk_mul_f32 v[62:63], v[62:63], v[98:99] op_sel:[0,1] op_sel_hi:[1,1]
    v_cvt_pk_bf16_f32 v166, v40, v41
    v_cvt_pk_bf16_f32 v167, v42, v43
    v_pk_mul_f32 v[64:65], v[64:65], v[100:101] op_sel:[0,1] op_sel_hi:[1,1]
    v_pk_mul_f32 v[66:67], v[66:67], v[100:101] op_sel:[0,1] op_sel_hi:[1,1]
    v_cvt_pk_bf16_f32 v168, v44, v45
    v_cvt_pk_bf16_f32 v169, v46, v47
    v_pk_mul_f32 v[68:69], v[68:69], v[102:103] op_sel:[0,1] op_sel_hi:[1,1]
    v_pk_mul_f32 v[70:71], v[70:71], v[102:103] op_sel:[0,1] op_sel_hi:[1,1]
    v_cvt_pk_bf16_f32 v170, v48, v49
    v_cvt_pk_bf16_f32 v171, v50, v51
    v_pk_mul_f32 v[72:73], v[72:73], v[104:105] op_sel:[0,1] op_sel_hi:[1,1]
    v_pk_mul_f32 v[74:75], v[74:75], v[104:105] op_sel:[0,1] op_sel_hi:[1,1]
    v_cvt_pk_bf16_f32 v172, v52, v53
    v_cvt_pk_bf16_f32 v173, v54, v55
    v_cvt_pk_bf16_f32 v174, v56, v57
    v_cvt_pk_bf16_f32 v175, v58, v59
    v_cvt_pk_bf16_f32 v176, v60, v61
    v_cvt_pk_bf16_f32 v177, v62, v63
    v_cvt_pk_bf16_f32 v178, v64, v65
    v_cvt_pk_bf16_f32 v179, v66, v67
    v_cvt_pk_bf16_f32 v180, v68, v69
    v_cvt_pk_bf16_f32 v181, v70, v71
    v_cvt_pk_bf16_f32 v182, v72, v73
    v_cvt_pk_bf16_f32 v183, v74, v75
    v_mfma_f32_16x16x16_bf16 v[196:199], v[174:175], v[166:167], v[32:35]
    v_mfma_f32_16x16x16_bf16 v[212:215], v[176:177], v[166:167], v[24:27]
    v_mfma_f32_16x16x16_bf16 v[200:203], v[176:177], v[168:169], v[28:31]
    v_mfma_f32_16x16x16_bf16 v[216:219], v[178:179], v[168:169], v[24:27]
    v_mfma_f32_16x16x16_bf16 v[204:207], v[178:179], v[170:171], v[28:31]
    v_mfma_f32_16x16x16_bf16 v[220:223], v[180:181], v[170:171], v[24:27]
    v_mfma_f32_16x16x16_bf16 v[208:211], v[180:181], v[172:173], v[28:31]
    v_mfma_f32_16x16x16_bf16 v[224:227], v[182:183], v[172:173], v[24:27]
    v_mov_b32 v244, s47
    v_mov_b32 v245, s47
    v_mov_b32 v246, s47
    v_mov_b32 v247, s47
    v_max3_f32 v248, v196, v197, v198
    v_max3_f32 v250, v200, v201, v202
    v_max3_f32 v252, v204, v205, v206
    v_max3_f32 v254, v208, v209, v210
    v_max3_f32 v248, v248, v199, v212
    v_max3_f32 v250, v250, v203, v216
    v_max3_f32 v252, v252, v207, v220
    v_max3_f32 v254, v254, v211, v224
    v_max3_f32 v248, v248, v213, v214
    v_max3_f32 v250, v250, v217, v218
    v_max3_f32 v252, v252, v221, v222
    v_max3_f32 v254, v254, v225, v226
    v_max_f32 v248, v248, v215
    v_max_f32 v250, v250, v219
    v_max_f32 v252, v252, v223
    v_max_f32 v254, v254, v227
    v_pk_fma_f32 v[76:77], v[108:109], v[156:157], v[76:77] op_sel:[0,0,0] op_sel_hi:[1,0,1] neg_lo:[1,0,0] neg_hi:[1,0,0]
    v_pk_fma_f32 v[78:79], v[110:111], v[156:157], v[78:79] op_sel:[0,0,0] op_sel_hi:[1,0,1] neg_lo:[1,0,0] neg_hi:[1,0,0]
    v_permlane32_swap_b32 v248, v250
    v_permlane32_swap_b32 v252, v254
    v_max_f32 v248, v248, v250
    v_max_f32 v252, v252, v254
    v_pk_fma_f32 v[80:81], v[112:113], v[156:157], v[80:81] op_sel:[0,0,0] op_sel_hi:[1,0,1] neg_lo:[1,0,0] neg_hi:[1,0,0]
    v_pk_fma_f32 v[82:83], v[114:115], v[156:157], v[82:83] op_sel:[0,0,0] op_sel_hi:[1,0,1] neg_lo:[1,0,0] neg_hi:[1,0,0]
    v_permlane16_swap_b32 v248, v252
    v_max_f32 v248, v248, v252
    v_mov_b32 v252, v248
    v_pk_fma_f32 v[84:85], v[116:117], v[156:157], v[84:85] op_sel:[0,0,0] op_sel_hi:[1,0,1] neg_lo:[1,0,0] neg_hi:[1,0,0]
    v_pk_fma_f32 v[86:87], v[118:119], v[156:157], v[86:87] op_sel:[0,0,0] op_sel_hi:[1,0,1] neg_lo:[1,0,0] neg_hi:[1,0,0]
    v_permlane16_swap_b32 v248, v252
    v_mov_b32 v250, v248
    v_mov_b32 v254, v252
    v_pk_fma_f32 v[88:89], v[120:121], v[156:157], v[88:89] op_sel:[0,0,0] op_sel_hi:[1,0,1] neg_lo:[1,0,0] neg_hi:[1,0,0]
    v_pk_fma_f32 v[90:91], v[122:123], v[156:157], v[90:91] op_sel:[0,0,0] op_sel_hi:[1,0,1] neg_lo:[1,0,0] neg_hi:[1,0,0]
    v_permlane32_swap_b32 v248, v250
    v_permlane32_swap_b32 v252, v254
    v_mul_f32 v248, v248, v158
    v_mul_f32 v250, v250, v160
    v_mul_f32 v252, v252, v162
    v_mul_f32 v254, v254, v164
    v_pk_fma_f32 v[92:93], v[124:125], v[156:157], v[92:93] op_sel:[0,0,0] op_sel_hi:[1,0,1] neg_lo:[1,0,0] neg_hi:[1,0,0]
    v_pk_fma_f32 v[94:95], v[126:127], v[156:157], v[94:95] op_sel:[0,0,0] op_sel_hi:[1,0,1] neg_lo:[1,0,0] neg_hi:[1,0,0]
    v_pk_mul_f32 v[76:77], v[76:77], v[128:129]
    v_pk_mul_f32 v[78:79], v[78:79], v[130:131]
    v_pk_mul_f32 v[80:81], v[80:81], v[132:133]
    v_pk_mul_f32 v[82:83], v[82:83], v[134:135]
    v_pk_mul_f32 v[84:85], v[84:85], v[136:137]
    v_pk_mul_f32 v[86:87], v[86:87], v[138:139]
    v_pk_mul_f32 v[88:89], v[88:89], v[140:141]
    v_pk_mul_f32 v[90:91], v[90:91], v[142:143]
    v_pk_mul_f32 v[92:93], v[92:93], v[144:145]
    v_pk_mul_f32 v[94:95], v[94:95], v[146:147]
    v_cvt_pk_bf16_f32 v184, v76, v77
    v_cvt_pk_bf16_f32 v185, v78, v79
    v_cvt_pk_bf16_f32 v186, v80, v81
    v_cvt_pk_bf16_f32 v187, v82, v83
    v_cvt_pk_bf16_f32 v188, v84, v85
    v_cvt_pk_bf16_f32 v189, v86, v87
    v_cvt_pk_bf16_f32 v190, v88, v89
    v_cvt_pk_bf16_f32 v191, v90, v91
    v_cvt_pk_bf16_f32 v192, v92, v93
    v_cvt_pk_bf16_f32 v193, v94, v95
    v_pk_fma_f32 v[196:197], v[196:197], v[158:159], v[248:249] op_sel:[0,0,0] op_sel_hi:[1,0,0] neg_lo:[0,0,1] neg_hi:[0,0,1]
    v_pk_fma_f32 v[198:199], v[198:199], v[158:159], v[248:249] op_sel:[0,0,0] op_sel_hi:[1,0,0] neg_lo:[0,0,1] neg_hi:[0,0,1]
    v_pk_fma_f32 v[212:213], v[212:213], v[158:159], v[248:249] op_sel:[0,0,0] op_sel_hi:[1,0,0] neg_lo:[0,0,1] neg_hi:[0,0,1]
    v_pk_fma_f32 v[214:215], v[214:215], v[158:159], v[248:249] op_sel:[0,0,0] op_sel_hi:[1,0,0] neg_lo:[0,0,1] neg_hi:[0,0,1]
    v_pk_fma_f32 v[200:201], v[200:201], v[160:161], v[250:251] op_sel:[0,0,0] op_sel_hi:[1,0,0] neg_lo:[0,0,1] neg_hi:[0,0,1]
    v_pk_fma_f32 v[202:203], v[202:203], v[160:161], v[250:251] op_sel:[0,0,0] op_sel_hi:[1,0,0] neg_lo:[0,0,1] neg_hi:[0,0,1]
    v_pk_fma_f32 v[216:217], v[216:217], v[160:161], v[250:251] op_sel:[0,0,0] op_sel_hi:[1,0,0] neg_lo:[0,0,1] neg_hi:[0,0,1]
    v_pk_fma_f32 v[218:219], v[218:219], v[160:161], v[250:251] op_sel:[0,0,0] op_sel_hi:[1,0,0] neg_lo:[0,0,1] neg_hi:[0,0,1]
    v_pk_fma_f32 v[204:205], v[204:205], v[162:163], v[252:253] op_sel:[0,0,0] op_sel_hi:[1,0,0] neg_lo:[0,0,1] neg_hi:[0,0,1]
    v_pk_fma_f32 v[206:207], v[206:207], v[162:163], v[252:253] op_sel:[0,0,0] op_sel_hi:[1,0,0] neg_lo:[0,0,1] neg_hi:[0,0,1]
    v_pk_fma_f32 v[220:221], v[220:221], v[162:163], v[252:253] op_sel:[0,0,0] op_sel_hi:[1,0,0] neg_lo:[0,0,1] neg_hi:[0,0,1]
    v_pk_fma_f32 v[222:223], v[222:223], v[162:163], v[252:253] op_sel:[0,0,0] op_sel_hi:[1,0,0] neg_lo:[0,0,1] neg_hi:[0,0,1]
    v_pk_fma_f32 v[208:209], v[208:209], v[164:165], v[254:255] op_sel:[0,0,0] op_sel_hi:[1,0,0] neg_lo:[0,0,1] neg_hi:[0,0,1]
    v_pk_fma_f32 v[210:211], v[210:211], v[164:165], v[254:255] op_sel:[0,0,0] op_sel_hi:[1,0,0] neg_lo:[0,0,1] neg_hi:[0,0,1]
    v_pk_fma_f32 v[224:225], v[224:225], v[164:165], v[254:255] op_sel:[0,0,0] op_sel_hi:[1,0,0] neg_lo:[0,0,1] neg_hi:[0,0,1]
    v_pk_fma_f32 v[226:227], v[226:227], v[164:165], v[254:255] op_sel:[0,0,0] op_sel_hi:[1,0,0] neg_lo:[0,0,1] neg_hi:[0,0,1]
    v_exp_f32 v196, v196
    v_exp_f32 v197, v197
    v_exp_f32 v198, v198
    v_exp_f32 v199, v199
    v_exp_f32 v212, v212
    v_exp_f32 v213, v213
    v_exp_f32 v214, v214
    v_exp_f32 v215, v215
    v_cvt_pk_bf16_f32 v228, v196, v197
    v_cvt_pk_bf16_f32 v229, v198, v199
    v_cvt_pk_bf16_f32 v230, v212, v213
    v_cvt_pk_bf16_f32 v231, v214, v215
    v_exp_f32 v200, v200
    v_exp_f32 v201, v201
    v_exp_f32 v202, v202
    v_exp_f32 v203, v203
    v_exp_f32 v216, v216
    v_exp_f32 v217, v217
    v_exp_f32 v218, v218
    v_exp_f32 v219, v219
    v_mfma_f32_16x16x32_bf16 v[60:63], v[244:247], v[228:231], 0
    v_mfma_f32_16x16x32_bf16 v[40:43], v[184:187], v[228:231], 0
    v_cvt_pk_bf16_f32 v232, v200, v201
    v_cvt_pk_bf16_f32 v233, v202, v203
    v_cvt_pk_bf16_f32 v234, v216, v217
    v_cvt_pk_bf16_f32 v235, v218, v219
    v_exp_f32 v204, v204
    v_exp_f32 v205, v205
    v_exp_f32 v206, v206
    v_exp_f32 v207, v207
    v_exp_f32 v220, v220
    v_exp_f32 v221, v221
    v_exp_f32 v222, v222
    v_exp_f32 v223, v223
    v_mfma_f32_16x16x32_bf16 v[64:67], v[244:247], v[232:235], 0
    v_mfma_f32_16x16x32_bf16 v[44:47], v[186:189], v[232:235], 0
    v_cvt_pk_bf16_f32 v236, v204, v205
    v_cvt_pk_bf16_f32 v237, v206, v207
    v_cvt_pk_bf16_f32 v238, v220, v221
    v_cvt_pk_bf16_f32 v239, v222, v223
    v_exp_f32 v208, v208
    v_exp_f32 v209, v209
    v_exp_f32 v210, v210
    v_exp_f32 v211, v211
    v_exp_f32 v224, v224
    v_exp_f32 v225, v225
    v_exp_f32 v226, v226
    v_exp_f32 v227, v227
    v_mfma_f32_16x16x32_bf16 v[68:71], v[244:247], v[236:239], 0
    v_mfma_f32_16x16x32_bf16 v[48:51], v[188:191], v[236:239], 0
    v_cvt_pk_bf16_f32 v240, v208, v209
    v_cvt_pk_bf16_f32 v241, v210, v211
    v_cvt_pk_bf16_f32 v242, v224, v225
    v_cvt_pk_bf16_f32 v243, v226, v227
    s_lshl_b32 s48, s54, 16
    s_lshl_b32 s49, s55, 2
    v_mfma_f32_16x16x32_bf16 v[72:75], v[244:247], v[240:243], 0
    v_mfma_f32_16x16x32_bf16 v[52:55], v[190:193], v[240:243], 0
    s_add_u32 s49, s49, s44
    s_lshl_b32 s49, s49, 10
    s_add_u32 s48, s48, s49
    s_add_u32 s49, s48, 32768
    v_rcp_f32 v60, v60
    v_rcp_f32 v64, v64
    v_mul_f32 v40, v40, v60
    v_mul_f32 v41, v41, v60
    v_mul_f32 v42, v42, v60
    v_mul_f32 v43, v43, v60
    v_mul_f32 v44, v44, v64
    v_mul_f32 v45, v45, v64
    v_mul_f32 v46, v46, v64
    v_mul_f32 v47, v47, v64
    v_cvt_pk_bf16_f32 v228, v40, v41
    v_cvt_pk_bf16_f32 v229, v42, v43
    v_cvt_pk_bf16_f32 v230, v44, v45
    v_cvt_pk_bf16_f32 v231, v46, v47
    s_nop 0
    v_permlane16_swap_b32 v228, v230
    v_permlane16_swap_b32 v229, v231
    buffer_store_dwordx4 v[228:231], v2, s[40:43], s48 offen sc1
    v_rcp_f32 v68, v68
    v_rcp_f32 v72, v72
    v_mul_f32 v48, v48, v68
    v_mul_f32 v49, v49, v68
    v_mul_f32 v50, v50, v68
    v_mul_f32 v51, v51, v68
    v_mul_f32 v52, v52, v72
    v_mul_f32 v53, v53, v72
    v_mul_f32 v54, v54, v72
    v_mul_f32 v55, v55, v72
    v_cvt_pk_bf16_f32 v232, v48, v49
    v_cvt_pk_bf16_f32 v233, v50, v51
    v_cvt_pk_bf16_f32 v234, v52, v53
    v_cvt_pk_bf16_f32 v235, v54, v55
    s_nop 0
    v_permlane16_swap_b32 v232, v234
    v_permlane16_swap_b32 v233, v235
    buffer_store_dwordx4 v[232:235], v2, s[40:43], s49 offen sc1
    s_lshl_b32 s50, s54, 3
    s_add_u32 s50, s50, s55
    s_lshl_b32 s50, s50, 7
    s_add_u32 s50, s50, 14680064
    s_lshr_b32 s54, s52, 0
    s_lshl_b32 s54, s54, 2
    s_lshr_b32 s55, s53, 3
    s_add_u32 s54, s54, s55
    s_and_b32 s55, s52, 0
    s_lshl_b32 s55, s55, 3
    s_and_b32 s48, s53, 7
    s_add_u32 s55, s55, s48
    s_and_b32 s56, s44, 1
    s_lshr_b32 s57, s44, 1
    s_lshl_b32 s58, s54, 1
    s_add_u32 s58, s58, s56
    s_lshl_b32 s59, s58, 15
    s_lshl_b32 s49, s57, 14
    s_add_u32 s59, s59, s49
    s_and_b32 s60, s55, 1
    v_bfe_u32 v3, v1, 3, 1
    v_xor_b32 v3, s57, v3
    v_lshlrev_b32 v12, 6, v3
    v_bfe_u32 v3, v1, 4, 1
    v_lshl_add_u32 v12, v3, 5, v12
    v_and_b32 v3, 1, v1
    v_lshl_add_u32 v12, v3, 4, v12
    v_bfe_u32 v3, v1, 1, 1
    v_lshl_add_u32 v12, v3, 3, v12
    v_bfe_u32 v3, v1, 2, 2
    v_lshl_add_u32 v12, v3, 7, v12
    v_lshrrev_b32 v3, 5, v1
    v_lshl_add_u32 v12, v3, 10, v12
    s_mul_i32 s48, s57, 32768
    v_add_u32 v12, s48, v12
    v_xor_b32 v13, 64, v12
    s_lshl_b32 s48, s44, 12
    s_add_u32 s48, s48, 131072
    v_add_u32 v16, s48, v2
    v_xor_b32 v17, 8192, v16
    v_lshrrev_b32 v3, 5, v1
    s_lshl_b32 s48, s57, 2
    v_or_b32 v3, s48, v3
    v_and_b32 v4, 7, v1
    v_xor_b32 v3, v3, v4
    v_lshlrev_b32 v14, 4, v3
    v_and_b32 v3, 31, v1
    v_lshl_add_u32 v14, v3, 7, v14
    s_lshl_b32 s48, s56, 12
    s_add_u32 s48, s48, 140288
    v_add_u32 v14, s48, v14
    v_xor_b32 v15, 32, v14
    s_lshl_b32 s48, s60, 14
    v_add_u32 v12, s48, v12
    v_add_u32 v13, s48, v13
    s_lshl_b32 s48, s60, 13
    s_add_u32 s59, s59, s48
    s_branch LE_3
LW_2:
    s_sleep 1
LE_3:
    ds_read_b32 v5, v11 offset:32
    s_waitcnt lgkmcnt(0)
    v_readfirstlane_b32 s48, v5
    s_nop 0
    s_cmp_lt_u32 s48, 1
    s_cbranch_scc1 LW_2
    s_mov_b32 s46, s48
    v_mov_b32 v4, 1
    s_mov_b64 exec, 1
    s_waitcnt vmcnt(0)
    ds_add_rtn_u32 v5, v11, v4 offset:0
    s_waitcnt lgkmcnt(0)
    v_readfirstlane_b32 s48, v5
    s_mov_b64 exec, -1
    s_cmp_lg_u32 s48, 3
    s_cbranch_scc1 SIG_4
    v_mov_b32 v3, s46
    v_lshlrev_b32 v4, 28, v1
    buffer_store_dword v3, v4, s[40:43], s50 offen sc1
SIG_4:
    s_branch LE_6
LW_5:
    s_sleep 1
LE_6:
    ds_read_b32 v5, v11 offset:40
    s_waitcnt lgkmcnt(0)
    v_readfirstlane_b32 s48, v5
    s_nop 0
    s_cmp_lt_u32 s48, 1
    s_cbranch_scc1 LW_5
    ds_read_b128 v[52:55], v14
    ds_read_b128 v[56:59], v15
    ds_read_b64_tr_b16 v[116:117], v12 offset:0
    ds_read_b64_tr_b16 v[118:119], v12 offset:512
    ds_read_b64_tr_b16 v[120:121], v13 offset:0
    ds_read_b64_tr_b16 v[122:123], v13 offset:512
    ds_read_b64_tr_b16 v[124:125], v12 offset:2048
    ds_read_b64_tr_b16 v[126:127], v12 offset:2560
    ds_read_b64_tr_b16 v[128:129], v13 offset:2048
    ds_read_b64_tr_b16 v[130:131], v13 offset:2560
    ds_read_b64_tr_b16 v[132:133], v12 offset:4096
    ds_read_b64_tr_b16 v[134:135], v12 offset:4608
    ds_read_b64_tr_b16 v[136:137], v13 offset:4096
    ds_read_b64_tr_b16 v[138:139], v13 offset:4608
    ds_read_b64_tr_b16 v[140:141], v12 offset:6144
    ds_read_b64_tr_b16 v[142:143], v12 offset:6656
    ds_read_b64_tr_b16 v[144:145], v13 offset:6144
    ds_read_b64_tr_b16 v[146:147], v13 offset:6656
    ds_read_b64_tr_b16 v[148:149], v12 offset:8192
    ds_read_b64_tr_b16 v[150:151], v12 offset:8704
    ds_read_b64_tr_b16 v[152:153], v13 offset:8192
    ds_read_b64_tr_b16 v[154:155], v13 offset:8704
    ds_read_b64_tr_b16 v[156:157], v12 offset:10240
    ds_read_b64_tr_b16 v[158:159], v12 offset:10752
    ds_read_b64_tr_b16 v[160:161], v13 offset:10240
    ds_read_b64_tr_b16 v[162:163], v13 offset:10752
    ds_read_b64_tr_b16 v[164:165], v12 offset:12288
    ds_read_b64_tr_b16 v[166:167], v12 offset:12800
    ds_read_b64_tr_b16 v[168:169], v13 offset:12288
    ds_read_b64_tr_b16 v[170:171], v13 offset:12800
    ds_read_b64_tr_b16 v[172:173], v12 offset:14336
    ds_read_b64_tr_b16 v[174:175], v12 offset:14848
    ds_read_b64_tr_b16 v[176:177], v13 offset:14336
    ds_read_b64_tr_b16 v[178:179], v13 offset:14848
    v_xor_b32 v12, 16384, v12
    v_xor_b32 v13, 16384, v13
    ds_read_b64_tr_b16 v[180:181], v12 offset:0
    ds_read_b64_tr_b16 v[182:183], v12 offset:512
    ds_read_b64_tr_b16 v[184:185], v13 offset:0
    ds_read_b64_tr_b16 v[186:187], v13 offset:512
    ds_read_b64_tr_b16 v[188:189], v12 offset:2048
    ds_read_b64_tr_b16 v[190:191], v12 offset:2560
    ds_read_b64_tr_b16 v[192:193], v13 offset:2048
    ds_read_b64_tr_b16 v[194:195], v13 offset:2560
    ds_read_b64_tr_b16 v[196:197], v12 offset:4096
    ds_read_b64_tr_b16 v[198:199], v12 offset:4608
    ds_read_b64_tr_b16 v[200:201], v13 offset:4096
    ds_read_b64_tr_b16 v[202:203], v13 offset:4608
    ds_read_b64_tr_b16 v[204:205], v12 offset:6144
    ds_read_b64_tr_b16 v[206:207], v12 offset:6656
    ds_read_b64_tr_b16 v[208:209], v13 offset:6144
    ds_read_b64_tr_b16 v[210:211], v13 offset:6656
    ds_read_b64_tr_b16 v[212:213], v12 offset:8192
    ds_read_b64_tr_b16 v[214:215], v12 offset:8704
    ds_read_b64_tr_b16 v[216:217], v13 offset:8192
    ds_read_b64_tr_b16 v[218:219], v13 offset:8704
    ds_read_b64_tr_b16 v[220:221], v12 offset:10240
    ds_read_b64_tr_b16 v[222:223], v12 offset:10752
    ds_read_b64_tr_b16 v[224:225], v13 offset:10240
    ds_read_b64_tr_b16 v[226:227], v13 offset:10752
    ds_read_b64_tr_b16 v[228:229], v12 offset:12288
    ds_read_b64_tr_b16 v[230:231], v12 offset:12800
    ds_read_b64_tr_b16 v[232:233], v13 offset:12288
    ds_read_b64_tr_b16 v[234:235], v13 offset:12800
    ds_read_b64_tr_b16 v[236:237], v12 offset:14336
    ds_read_b64_tr_b16 v[238:239], v12 offset:14848
    ds_read_b64_tr_b16 v[240:241], v13 offset:14336
    ds_read_b64_tr_b16 v[242:243], v13 offset:14848
    s_waitcnt lgkmcnt(0)
    v_mov_b32 v4, 1
    s_mov_b64 exec, 1
    ds_add_u32 v11, v4 offset:44
    s_mov_b64 exec, -1
    v_lshlrev_b32 v20, 16, v52
    v_and_b32 v21, 0xffff0000, v52
    v_lshlrev_b32 v22, 16, v53
    v_and_b32 v23, 0xffff0000, v53
    v_lshlrev_b32 v24, 16, v54
    v_and_b32 v25, 0xffff0000, v54
    v_lshlrev_b32 v26, 16, v55
    v_and_b32 v27, 0xffff0000, v55
    v_lshlrev_b32 v28, 16, v56
    v_and_b32 v29, 0xffff0000, v56
    v_lshlrev_b32 v30, 16, v57
    v_and_b32 v31, 0xffff0000, v57
    v_lshlrev_b32 v32, 16, v58
    v_and_b32 v33, 0xffff0000, v58
    v_lshlrev_b32 v34, 16, v59
    v_and_b32 v35, 0xffff0000, v59
    s_cmp_lg_u32 s44, 0
    s_cbranch_scc1 P2_NOP
    s_lshl_b32 s50, s54, 10
    s_add_u32 s50, s50, 14680064
    v_min_u32 v10, 7, v1
    v_lshlrev_b32 v10, 7, v10
    s_mov_b32 s49, 0x40000
    buffer_load_dword v8, v10, s[40:43], s50 offen sc1
    s_sleep 4
POLL_7:
    buffer_load_dword v9, v10, s[40:43], s50 offen sc1
    s_waitcnt vmcnt(1)
    v_cmp_ne_u32 vcc, s46, v8
    s_nop 4
    s_cbranch_vccz POLLD_8
    buffer_load_dword v8, v10, s[40:43], s50 offen sc1
    s_waitcnt vmcnt(1)
    v_cmp_ne_u32 vcc, s46, v9
    s_nop 4
    s_cbranch_vccz POLLD_8
    s_sub_u32 s49, s49, 1
    s_cbranch_scc0 POLL_7
POLLD_8:
    v_mov_b32 v4, 1
    s_mov_b64 exec, 1
    ds_add_u32 v11, v4 offset:48
    s_mov_b64 exec, -1
    s_branch P2_GO
P2_NOP:
    s_branch LE_10
LW_9:
    s_sleep 1
LE_10:
    ds_read_b32 v5, v11 offset:48
    s_waitcnt lgkmcnt(0)
    v_readfirstlane_b32 s48, v5
    s_nop 0
    s_cmp_lt_u32 s48, 1
    s_cbranch_scc1 LW_9
P2_GO:
    buffer_load_dwordx4 v[52:55], v2, s[40:43], s59 offen offset:0 sc1
    buffer_load_dwordx4 v[56:59], v2, s[40:43], s59 offen offset:1024 sc1
    buffer_load_dwordx4 v[60:63], v2, s[40:43], s59 offen offset:2048 sc1
    buffer_load_dwordx4 v[64:67], v2, s[40:43], s59 offen offset:3072 sc1
    s_add_u32 s59, s59, 4096
    buffer_load_dwordx4 v[68:71], v2, s[40:43], s59 offen offset:0 sc1
    buffer_load_dwordx4 v[72:75], v2, s[40:43], s59 offen offset:1024 sc1
    buffer_load_dwordx4 v[76:79], v2, s[40:43], s59 offen offset:2048 sc1
    buffer_load_dwordx4 v[80:83], v2, s[40:43], s59 offen offset:3072 sc1
    s_xor_b32 s59, s59, 12288
    buffer_load_dwordx4 v[84:87], v2, s[40:43], s59 offen offset:0 sc1
    buffer_load_dwordx4 v[88:91], v2, s[40:43], s59 offen offset:1024 sc1
    buffer_load_dwordx4 v[92:95], v2, s[40:43], s59 offen offset:2048 sc1
    buffer_load_dwordx4 v[96:99], v2, s[40:43], s59 offen offset:3072 sc1
    s_add_u32 s59, s59, 4096
    buffer_load_dwordx4 v[100:103], v2, s[40:43], s59 offen offset:0 sc1
    buffer_load_dwordx4 v[104:107], v2, s[40:43], s59 offen offset:1024 sc1
    buffer_load_dwordx4 v[108:111], v2, s[40:43], s59 offen offset:2048 sc1
    buffer_load_dwordx4 v[112:115], v2, s[40:43], s59 offen offset:3072 sc1
    v_mov_b32 v4, 1
    s_mov_b64 exec, 1
    ds_add_u32 v11, v4 offset:60
    s_mov_b64 exec, -1
    s_lshl_b32 s50, s58, 15
    s_lshl_b32 s48, s55, 12
    s_add_u32 s50, s50, s48
    s_lshl_b32 s49, s57, 11
    s_add_u32 s50, s50, s49
    s_add_u32 s50, s50, 2097152
    s_lshl_b32 s51, s58, 4
    s_lshl_b32 s49, s55, 1
    s_add_u32 s51, s51, s49
    s_add_u32 s51, s51, s57
    s_lshl_b32 s51, s51, 8
    v_lshlrev_b32 v14, 2, v1
    s_add_u32 s51, s51, 12582912
    s_lshl_b32 s94, s54, 3
    s_add_u32 s94, s94, s55
    s_lshl_b32 s94, s94, 7
    s_add_u32 s94, s94, 14811136
    s_waitcnt vmcnt(15)
    v_mfma_f32_32x32x16_bf16 v[36:51], v[120:123], v[52:55], 0
    v_mfma_f32_32x32x16_bf16 v[20:35], v[116:119], v[52:55], v[20:35]
    s_waitcnt vmcnt(14)
    v_mfma_f32_32x32x16_bf16 v[36:51], v[128:131], v[56:59], v[36:51]
    v_mfma_f32_32x32x16_bf16 v[20:35], v[124:127], v[56:59], v[20:35]
    s_waitcnt vmcnt(13)
    v_mfma_f32_32x32x16_bf16 v[36:51], v[136:139], v[60:63], v[36:51]
    v_mfma_f32_32x32x16_bf16 v[20:35], v[132:135], v[60:63], v[20:35]
    s_waitcnt vmcnt(12)
    v_mfma_f32_32x32x16_bf16 v[36:51], v[144:147], v[64:67], v[36:51]
    v_mfma_f32_32x32x16_bf16 v[20:35], v[140:143], v[64:67], v[20:35]
    s_waitcnt vmcnt(11)
    v_mfma_f32_32x32x16_bf16 v[36:51], v[152:155], v[68:71], v[36:51]
    v_mfma_f32_32x32x16_bf16 v[20:35], v[148:151], v[68:71], v[20:35]
    s_waitcnt vmcnt(10)
    v_mfma_f32_32x32x16_bf16 v[36:51], v[160:163], v[72:75], v[36:51]
    v_mfma_f32_32x32x16_bf16 v[20:35], v[156:159], v[72:75], v[20:35]
    s_waitcnt vmcnt(9)
    v_mfma_f32_32x32x16_bf16 v[36:51], v[168:171], v[76:79], v[36:51]
    v_mfma_f32_32x32x16_bf16 v[20:35], v[164:167], v[76:79], v[20:35]
    s_waitcnt vmcnt(8)
    v_mfma_f32_32x32x16_bf16 v[36:51], v[176:179], v[80:83], v[36:51]
    v_mfma_f32_32x32x16_bf16 v[20:35], v[172:175], v[80:83], v[20:35]
    s_waitcnt vmcnt(7)
    v_mfma_f32_32x32x16_bf16 v[36:51], v[184:187], v[84:87], v[36:51]
    v_mfma_f32_32x32x16_bf16 v[20:35], v[180:183], v[84:87], v[20:35]
    s_waitcnt vmcnt(6)
    v_mfma_f32_32x32x16_bf16 v[36:51], v[192:195], v[88:91], v[36:51]
    v_mfma_f32_32x32x16_bf16 v[20:35], v[188:191], v[88:91], v[20:35]
    s_waitcnt vmcnt(5)
    v_mfma_f32_32x32x16_bf16 v[36:51], v[200:203], v[92:95], v[36:51]
    v_mfma_f32_32x32x16_bf16 v[20:35], v[196:199], v[92:95], v[20:35]
    s_waitcnt vmcnt(4)
    v_mfma_f32_32x32x16_bf16 v[36:51], v[208:211], v[96:99], v[36:51]
    v_mfma_f32_32x32x16_bf16 v[20:35], v[204:207], v[96:99], v[20:35]
    s_waitcnt vmcnt(3)
    v_mfma_f32_32x32x16_bf16 v[36:51], v[216:219], v[100:103], v[36:51]
    v_mfma_f32_32x32x16_bf16 v[20:35], v[212:215], v[100:103], v[20:35]
    s_waitcnt vmcnt(2)
    v_mfma_f32_32x32x16_bf16 v[36:51], v[224:227], v[104:107], v[36:51]
    v_mfma_f32_32x32x16_bf16 v[20:35], v[220:223], v[104:107], v[20:35]
    s_waitcnt vmcnt(1)
    v_mfma_f32_32x32x16_bf16 v[36:51], v[232:235], v[108:111], v[36:51]
    v_mfma_f32_32x32x16_bf16 v[20:35], v[228:231], v[108:111], v[20:35]
    s_waitcnt vmcnt(0)
    v_mfma_f32_32x32x16_bf16 v[36:51], v[240:243], v[112:115], v[36:51]
    v_mfma_f32_32x32x16_bf16 v[20:35], v[236:239], v[112:115], v[20:35]
    s_nop 10
    ds_write_b128 v16, v[36:39] offset:0
    ds_write_b128 v16, v[40:43] offset:1024
    ds_write_b128 v16, v[44:47] offset:2048
    ds_write_b128 v16, v[48:51] offset:3072
    s_lshl_b32 s48, s44, 2
    s_add_u32 s48, s48, 152592
    v_mov_b32 v3, s48
    v_mov_b32 v4, 1
    ds_write_b32 v3, v4
    v_xor_b32 v3, 8, v3
EXS_11:
    ds_read_b32 v5, v3
    ds_read_b128 v[116:119], v17 offset:0
    ds_read_b128 v[120:123], v17 offset:1024
    ds_read_b128 v[124:127], v17 offset:2048
    ds_read_b128 v[128:131], v17 offset:3072
    s_waitcnt lgkmcnt(4)
    v_readfirstlane_b32 s48, v5
    s_nop 0
    s_cmp_eq_u32 s48, 0
    s_cbranch_scc1 EXS_11
    s_waitcnt lgkmcnt(3)
    v_pk_add_f32 v[20:21], v[20:21], v[116:117]
    v_pk_add_f32 v[22:23], v[22:23], v[118:119]
    s_waitcnt lgkmcnt(2)
    v_pk_add_f32 v[24:25], v[24:25], v[120:121]
    v_pk_add_f32 v[26:27], v[26:27], v[122:123]
    s_waitcnt lgkmcnt(1)
    v_pk_add_f32 v[28:29], v[28:29], v[124:125]
    v_pk_add_f32 v[30:31], v[30:31], v[126:127]
    s_waitcnt lgkmcnt(0)
    v_pk_add_f32 v[32:33], v[32:33], v[128:129]
    v_pk_add_f32 v[34:35], v[34:35], v[130:131]
    v_cvt_pk_bf16_f32 v148, v20, v21
    v_cvt_pk_bf16_f32 v149, v22, v23
    v_cvt_pk_bf16_f32 v150, v24, v25
    v_cvt_pk_bf16_f32 v151, v26, v27
    buffer_store_dwordx4 v[148:151], v2, s[40:43], s50 offen offset:0 sc1
    v_cvt_pk_bf16_f32 v152, v28, v29
    v_cvt_pk_bf16_f32 v153, v30, v31
    v_cvt_pk_bf16_f32 v154, v32, v33
    v_cvt_pk_bf16_f32 v155, v34, v35
    buffer_store_dwordx4 v[152:155], v2, s[40:43], s50 offen offset:1024 sc1
    v_mov_b32 v156, 0
    v_mov_b32 v157, 0
    v_dot2c_f32_bf16 v156, s47, v148
    v_dot2c_f32_bf16 v157, v148, v148
    v_dot2c_f32_bf16 v156, s47, v149
    v_dot2c_f32_bf16 v157, v149, v149
    v_dot2c_f32_bf16 v156, s47, v150
    v_dot2c_f32_bf16 v157, v150, v150
    v_dot2c_f32_bf16 v156, s47, v151
    v_dot2c_f32_bf16 v157, v151, v151
    v_dot2c_f32_bf16 v156, s47, v152
    v_dot2c_f32_bf16 v157, v152, v152
    v_dot2c_f32_bf16 v156, s47, v153
    v_dot2c_f32_bf16 v157, v153, v153
    v_dot2c_f32_bf16 v156, s47, v154
    v_dot2c_f32_bf16 v157, v154, v154
    v_dot2c_f32_bf16 v156, s47, v155
    v_dot2c_f32_bf16 v157, v155, v155
    s_nop 2
    v_permlane32_swap_b32 v156, v157
    v_add_f32 v156, v156, v157
    buffer_store_dword v156, v14, s[40:43], s51 offen sc1
    s_branch P3_START
P1_LOAD:
    v_mov_b32 v32, 0
    s_add_u32 s57, s54, s55
    s_and_b32 s57, s57, 3
    s_mul_i32 s57, s57, 2
    v_lshrrev_b32 v3, 3, v1
    v_and_b32 v4, 7, v1
    v_lshrrev_b32 v5, 1, v3
    v_xor_b32 v5, v5, v4
    v_lshlrev_b32 v14, 4, v5
    v_lshl_add_u32 v14, v3, 11, v14
    v_add_u32 v14, s56, v14
    v_xor_b32 v18, 64, v14
    v_add_u32 v15, 15360, v18
    v_add_u32 v16, 30720, v14
    v_add_u32 v17, 46080, v18
    v_subrev_u32 v18, 16384, v18
    v_and_b32 v5, 2, v3
    v_xor_b32 v5, v5, v4
    v_lshlrev_b32 v12, 4, v5
    v_xor_b32 v13, 64, v12
    v_mul_u32_u24 v5, 3072, v3
    s_lshl_b32 s50, s55, 7
    v_add_u32 v5, s50, v5
    v_add_u32 v12, v12, v5
    v_add_u32 v13, v13, v5
    v_add_u32 v13, 24576, v13
    s_lshl_b32 s59, s57, 7
    s_mul_i32 s58, s57, 196608
    s_waitcnt lgkmcnt(0)
    s_mov_b32 s24, s4
    s_and_b32 s25, s5, 0xffff
    s_mov_b32 s26, 0x200000
    s_mov_b32 s27, 0x20000
    s_mov_b32 m0, 1024
    s_add_u32 s48, s59, 65536
    buffer_load_dwordx4 v18, s[24:27], s59 offen lds
    s_mov_b32 m0, 2048
    s_nop 0
    buffer_load_dwordx4 v14, s[24:27], s59 offen offset:0 lds
    buffer_load_dwordx4 v15, s[24:27], s59 offen offset:1024 lds
    buffer_load_dwordx4 v16, s[24:27], s59 offen offset:2048 lds
    buffer_load_dwordx4 v17, s[24:27], s59 offen offset:3072 lds
    s_mov_b32 m0, 6144
    s_add_u32 s59, s59, 128
    buffer_load_dwordx4 v14, s[24:27], s48 offen offset:0 lds
    buffer_load_dwordx4 v15, s[24:27], s48 offen offset:1024 lds
    buffer_load_dwordx4 v16, s[24:27], s48 offen offset:2048 lds
    buffer_load_dwordx4 v17, s[24:27], s48 offen offset:3072 lds
    s_and_b32 s59, s59, 1023
    s_mov_b32 s28, s6
    s_and_b32 s29, s7, 0xffff
    s_mov_b32 s30, 0x180000
    s_mov_b32 s31, 0x20000
    s_mov_b32 m0, 10240
    s_nop 0
    buffer_load_dwordx4 v12, s[28:31], s58 offen offset:0 lds
    buffer_load_dwordx4 v12, s[28:31], s58 offen offset:1024 lds
    buffer_load_dwordx4 v12, s[28:31], s58 offen offset:2048 lds
    s_mov_b32 m0, 13312
    s_nop 0
    buffer_load_dwordx4 v13, s[28:31], s58 offen offset:0 lds
    buffer_load_dwordx4 v13, s[28:31], s58 offen offset:1024 lds
    buffer_load_dwordx4 v13, s[28:31], s58 offen offset:2048 lds
    s_mov_b32 m0, 16384
    s_add_u32 s58, s58, 49152
    buffer_load_dwordx4 v12, s[28:31], s58 offen offset:0 lds
    buffer_load_dwordx4 v12, s[28:31], s58 offen offset:1024 lds
    buffer_load_dwordx4 v12, s[28:31], s58 offen offset:2048 lds
    s_mov_b32 m0, 19456
    s_nop 0
    buffer_load_dwordx4 v13, s[28:31], s58 offen offset:0 lds
    buffer_load_dwordx4 v13, s[28:31], s58 offen offset:1024 lds
    buffer_load_dwordx4 v13, s[28:31], s58 offen offset:2048 lds
    s_mov_b32 m0, 22528
    s_add_u32 s58, s58, 49152
    buffer_load_dwordx4 v12, s[28:31], s58 offen offset:0 lds
    buffer_load_dwordx4 v12, s[28:31], s58 offen offset:1024 lds
    buffer_load_dwordx4 v12, s[28:31], s58 offen offset:2048 lds
    s_mov_b32 m0, 25600
    s_nop 0
    buffer_load_dwordx4 v13, s[28:31], s58 offen offset:0 lds
    buffer_load_dwordx4 v13, s[28:31], s58 offen offset:1024 lds
    buffer_load_dwordx4 v13, s[28:31], s58 offen offset:2048 lds
    s_mov_b32 m0, 28672
    s_add_u32 s58, s58, 49152
    buffer_load_dwordx4 v12, s[28:31], s58 offen offset:0 lds
    buffer_load_dwordx4 v12, s[28:31], s58 offen offset:1024 lds
    buffer_load_dwordx4 v12, s[28:31], s58 offen offset:2048 lds
    s_mov_b32 m0, 31744
    s_nop 0
    buffer_load_dwordx4 v13, s[28:31], s58 offen offset:0 lds
    buffer_load_dwordx4 v13, s[28:31], s58 offen offset:1024 lds
    buffer_load_dwordx4 v13, s[28:31], s58 offen offset:2048 lds
    s_add_u32 s58, s58, 49152
    s_cmp_eq_u32 s58, 1572864
    s_cselect_b32 s58, 0, s58
    s_mov_b32 m0, 35840
    s_add_u32 s48, s59, 65536
    buffer_load_dwordx4 v18, s[24:27], s59 offen lds
    s_mov_b32 m0, 36864
    s_nop 0
    buffer_load_dwordx4 v14, s[24:27], s59 offen offset:0 lds
    buffer_load_dwordx4 v15, s[24:27], s59 offen offset:1024 lds
    buffer_load_dwordx4 v16, s[24:27], s59 offen offset:2048 lds
    buffer_load_dwordx4 v17, s[24:27], s59 offen offset:3072 lds
    s_mov_b32 m0, 40960
    s_add_u32 s59, s59, 128
    buffer_load_dwordx4 v14, s[24:27], s48 offen offset:0 lds
    buffer_load_dwordx4 v15, s[24:27], s48 offen offset:1024 lds
    buffer_load_dwordx4 v16, s[24:27], s48 offen offset:2048 lds
    buffer_load_dwordx4 v17, s[24:27], s48 offen offset:3072 lds
    s_and_b32 s59, s59, 1023
    s_mov_b32 s40, s22
    s_and_b32 s41, s23, 0xffff
    s_mov_b32 s42, 0x2000000
    s_mov_b32 s43, 0x20000
    v_lshrrev_b32 v3, 3, v1
    v_and_b32 v4, 2, v3
    v_lshlrev_b32 v4, 1, v4
    v_and_b32 v20, 7, v1
    v_xor_b32 v20, v20, v4
    v_lshlrev_b32 v20, 4, v20
    v_lshl_add_u32 v20, v3, 10, v20
    v_add_u32 v21, 7168, v20
    v_add_u32 v22, 14336, v20
    v_add_u32 v23, 21504, v20
    v_and_b32 v24, 7, v1
    v_xor_b32 v24, v24, v3
    v_lshlrev_b32 v24, 4, v24
    v_lshl_add_u32 v24, v3, 11, v24
    v_add_u32 v25, 15360, v24
    v_add_u32 v26, 30720, v24
    v_add_u32 v27, 46080, v24
    s_lshr_b32 s92, s52, 0
    s_lshl_b32 s92, s92, 2
    s_lshr_b32 s93, s53, 3
    s_add_u32 s92, s92, s93
    s_and_b32 s93, s52, 0
    s_lshl_b32 s93, s93, 3
    s_and_b32 s48, s53, 7
    s_add_u32 s93, s93, s48
    s_lshr_b32 s94, s92, 1
    s_lshl_b32 s94, s94, 17
    s_and_b32 s48, s92, 1
    s_lshl_b32 s48, s48, 10
    s_add_u32 s94, s94, s48
    s_lshl_b32 s93, s93, 7
    s_mov_b32 s32, s8
    s_and_b32 s33, s9, 0xffff
    s_mov_b32 s34, 0x80000
    s_mov_b32 s35, 0x20000
    s_mov_b32 s36, s12
    s_and_b32 s37, s13, 0xffff
    s_mov_b32 s38, 0x1c0000
    s_mov_b32 s39, 0x20000
    v_and_b32 v255, 7, v1
    v_min_u32 v255, 6, v255
    v_lshlrev_b32 v255, 7, v255
    v_lshrrev_b32 v3, 3, v1
    v_mul_u32_u24 v3, 3584, v3
    v_add_u32 v255, v255, v3
    s_lshr_b32 s95, s52, 2
    s_lshl_b32 s95, s95, 5
    s_add_u32 s95, s95, s53
    s_mul_i32 s95, s95, 28672
    s_and_b32 s49, s52, 3
    s_mul_i32 s49, s49, 896
    s_add_u32 s95, s95, s49
    s_mov_b32 m0, 45056
    s_nop 0
    buffer_load_dwordx4 v12, s[28:31], s58 offen offset:0 lds
    buffer_load_dwordx4 v12, s[28:31], s58 offen offset:1024 lds
    buffer_load_dwordx4 v12, s[28:31], s58 offen offset:2048 lds
    s_mov_b32 m0, 48128
    s_nop 0
    buffer_load_dwordx4 v13, s[28:31], s58 offen offset:0 lds
    buffer_load_dwordx4 v13, s[28:31], s58 offen offset:1024 lds
    buffer_load_dwordx4 v13, s[28:31], s58 offen offset:2048 lds
    s_mov_b32 m0, 51200
    s_add_u32 s58, s58, 49152
    buffer_load_dwordx4 v12, s[28:31], s58 offen offset:0 lds
    buffer_load_dwordx4 v12, s[28:31], s58 offen offset:1024 lds
    buffer_load_dwordx4 v12, s[28:31], s58 offen offset:2048 lds
    s_mov_b32 m0, 54272
    s_nop 0
    buffer_load_dwordx4 v13, s[28:31], s58 offen offset:0 lds
    buffer_load_dwordx4 v13, s[28:31], s58 offen offset:1024 lds
    buffer_load_dwordx4 v13, s[28:31], s58 offen offset:2048 lds
    s_mov_b32 m0, 57344
    s_add_u32 s58, s58, 49152
    buffer_load_dwordx4 v12, s[28:31], s58 offen offset:0 lds
    buffer_load_dwordx4 v12, s[28:31], s58 offen offset:1024 lds
    buffer_load_dwordx4 v12, s[28:31], s58 offen offset:2048 lds
    s_mov_b32 m0, 60416
    s_nop 0
    buffer_load_dwordx4 v13, s[28:31], s58 offen offset:0 lds
    buffer_load_dwordx4 v13, s[28:31], s58 offen offset:1024 lds
    buffer_load_dwordx4 v13, s[28:31], s58 offen offset:2048 lds
    s_mov_b32 m0, 63488
    s_add_u32 s58, s58, 49152
    buffer_load_dwordx4 v12, s[28:31], s58 offen offset:0 lds
    buffer_load_dwordx4 v12, s[28:31], s58 offen offset:1024 lds
    buffer_load_dwordx4 v12, s[28:31], s58 offen offset:2048 lds
    s_mov_b32 m0, 66560
    s_nop 0
    buffer_load_dwordx4 v13, s[28:31], s58 offen offset:0 lds
    buffer_load_dwordx4 v13, s[28:31], s58 offen offset:1024 lds
    buffer_load_dwordx4 v13, s[28:31], s58 offen offset:2048 lds
    s_add_u32 s58, s58, 49152
    s_cmp_eq_u32 s58, 1572864
    s_cselect_b32 s58, 0, s58
    s_mov_b32 m0, 70656
    s_add_u32 s48, s59, 65536
    buffer_load_dwordx4 v18, s[24:27], s59 offen lds
    s_mov_b32 m0, 71680
    s_nop 0
    buffer_load_dwordx4 v14, s[24:27], s59 offen offset:0 lds
    buffer_load_dwordx4 v15, s[24:27], s59 offen offset:1024 lds
    buffer_load_dwordx4 v16, s[24:27], s59 offen offset:2048 lds
    buffer_load_dwordx4 v17, s[24:27], s59 offen offset:3072 lds
    s_mov_b32 m0, 75776
    s_add_u32 s59, s59, 128
    buffer_load_dwordx4 v14, s[24:27], s48 offen offset:0 lds
    buffer_load_dwordx4 v15, s[24:27], s48 offen offset:1024 lds
    buffer_load_dwordx4 v16, s[24:27], s48 offen offset:2048 lds
    buffer_load_dwordx4 v17, s[24:27], s48 offen offset:3072 lds
    s_and_b32 s59, s59, 1023
    s_waitcnt vmcnt(33)
    s_barrier
    s_mov_b32 m0, 79872
    s_nop 0
    buffer_load_dwordx4 v12, s[28:31], s58 offen offset:0 lds
    buffer_load_dwordx4 v12, s[28:31], s58 offen offset:1024 lds
    buffer_load_dwordx4 v12, s[28:31], s58 offen offset:2048 lds
    s_mov_b32 m0, 82944
    s_nop 0
    buffer_load_dwordx4 v13, s[28:31], s58 offen offset:0 lds
    buffer_load_dwordx4 v13, s[28:31], s58 offen offset:1024 lds
    buffer_load_dwordx4 v13, s[28:31], s58 offen offset:2048 lds
    s_mov_b32 m0, 86016
    s_add_u32 s58, s58, 49152
    buffer_load_dwordx4 v12, s[28:31], s58 offen offset:0 lds
    buffer_load_dwordx4 v12, s[28:31], s58 offen offset:1024 lds
    buffer_load_dwordx4 v12, s[28:31], s58 offen offset:2048 lds
    s_mov_b32 m0, 89088
    s_nop 0
    buffer_load_dwordx4 v13, s[28:31], s58 offen offset:0 lds
    buffer_load_dwordx4 v13, s[28:31], s58 offen offset:1024 lds
    buffer_load_dwordx4 v13, s[28:31], s58 offen offset:2048 lds
    s_mov_b32 m0, 92160
    s_add_u32 s58, s58, 49152
    buffer_load_dwordx4 v12, s[28:31], s58 offen offset:0 lds
    buffer_load_dwordx4 v12, s[28:31], s58 offen offset:1024 lds
    buffer_load_dwordx4 v12, s[28:31], s58 offen offset:2048 lds
    s_mov_b32 m0, 95232
    s_nop 0
    buffer_load_dwordx4 v13, s[28:31], s58 offen offset:0 lds
    buffer_load_dwordx4 v13, s[28:31], s58 offen offset:1024 lds
    buffer_load_dwordx4 v13, s[28:31], s58 offen offset:2048 lds
    s_mov_b32 m0, 98304
    s_add_u32 s58, s58, 49152
    buffer_load_dwordx4 v12, s[28:31], s58 offen offset:0 lds
    buffer_load_dwordx4 v12, s[28:31], s58 offen offset:1024 lds
    buffer_load_dwordx4 v12, s[28:31], s58 offen offset:2048 lds
    s_mov_b32 m0, 101376
    s_nop 0
    buffer_load_dwordx4 v13, s[28:31], s58 offen offset:0 lds
    buffer_load_dwordx4 v13, s[28:31], s58 offen offset:1024 lds
    buffer_load_dwordx4 v13, s[28:31], s58 offen offset:2048 lds
    s_add_u32 s58, s58, 49152
    s_cmp_eq_u32 s58, 1572864
    s_cselect_b32 s58, 0, s58
    s_mov_b32 m0, 105472
    s_add_u32 s48, s59, 65536
    buffer_load_dwordx4 v18, s[24:27], s59 offen lds
    s_mov_b32 m0, 106496
    s_nop 0
    buffer_load_dwordx4 v14, s[24:27], s59 offen offset:0 lds
    buffer_load_dwordx4 v15, s[24:27], s59 offen offset:1024 lds
    buffer_load_dwordx4 v16, s[24:27], s59 offen offset:2048 lds
    buffer_load_dwordx4 v17, s[24:27], s59 offen offset:3072 lds
    s_mov_b32 m0, 110592
    s_add_u32 s59, s59, 128
    buffer_load_dwordx4 v14, s[24:27], s48 offen offset:0 lds
    buffer_load_dwordx4 v15, s[24:27], s48 offen offset:1024 lds
    buffer_load_dwordx4 v16, s[24:27], s48 offen offset:2048 lds
    buffer_load_dwordx4 v17, s[24:27], s48 offen offset:3072 lds
    s_and_b32 s59, s59, 1023
    s_waitcnt vmcnt(33)
    s_barrier
    s_mov_b32 m0, 114688
    s_nop 0
    buffer_load_dwordx4 v12, s[28:31], s58 offen offset:0 lds
    buffer_load_dwordx4 v12, s[28:31], s58 offen offset:1024 lds
    buffer_load_dwordx4 v12, s[28:31], s58 offen offset:2048 lds
    s_mov_b32 m0, 117760
    s_nop 0
    buffer_load_dwordx4 v13, s[28:31], s58 offen offset:0 lds
    buffer_load_dwordx4 v13, s[28:31], s58 offen offset:1024 lds
    buffer_load_dwordx4 v13, s[28:31], s58 offen offset:2048 lds
    s_mov_b32 m0, 120832
    s_add_u32 s58, s58, 49152
    buffer_load_dwordx4 v12, s[28:31], s58 offen offset:0 lds
    buffer_load_dwordx4 v12, s[28:31], s58 offen offset:1024 lds
    buffer_load_dwordx4 v12, s[28:31], s58 offen offset:2048 lds
    s_mov_b32 m0, 123904
    s_nop 0
    buffer_load_dwordx4 v13, s[28:31], s58 offen offset:0 lds
    buffer_load_dwordx4 v13, s[28:31], s58 offen offset:1024 lds
    buffer_load_dwordx4 v13, s[28:31], s58 offen offset:2048 lds
    s_mov_b32 m0, 126976
    s_add_u32 s58, s58, 49152
    buffer_load_dwordx4 v12, s[28:31], s58 offen offset:0 lds
    buffer_load_dwordx4 v12, s[28:31], s58 offen offset:1024 lds
    buffer_load_dwordx4 v12, s[28:31], s58 offen offset:2048 lds
    s_mov_b32 m0, 130048
    s_nop 0
    buffer_load_dwordx4 v13, s[28:31], s58 offen offset:0 lds
    buffer_load_dwordx4 v13, s[28:31], s58 offen offset:1024 lds
    buffer_load_dwordx4 v13, s[28:31], s58 offen offset:2048 lds
    s_mov_b32 m0, 133120
    s_add_u32 s58, s58, 49152
    buffer_load_dwordx4 v12, s[28:31], s58 offen offset:0 lds
    buffer_load_dwordx4 v12, s[28:31], s58 offen offset:1024 lds
    buffer_load_dwordx4 v12, s[28:31], s58 offen offset:2048 lds
    s_mov_b32 m0, 136192
    s_nop 0
    buffer_load_dwordx4 v13, s[28:31], s58 offen offset:0 lds
    buffer_load_dwordx4 v13, s[28:31], s58 offen offset:1024 lds
    buffer_load_dwordx4 v13, s[28:31], s58 offen offset:2048 lds
    s_add_u32 s58, s58, 49152
    s_cmp_eq_u32 s58, 1572864
    s_cselect_b32 s58, 0, s58
    s_mov_b32 m0, 1024
    s_add_u32 s48, s59, 65536
    buffer_load_dwordx4 v18, s[24:27], s59 offen lds
    s_mov_b32 m0, 2048
    s_nop 0
    buffer_load_dwordx4 v14, s[24:27], s59 offen offset:0 lds
    buffer_load_dwordx4 v15, s[24:27], s59 offen offset:1024 lds
    buffer_load_dwordx4 v16, s[24:27], s59 offen offset:2048 lds
    buffer_load_dwordx4 v17, s[24:27], s59 offen offset:3072 lds
    s_mov_b32 m0, 6144
    s_add_u32 s59, s59, 128
    buffer_load_dwordx4 v14, s[24:27], s48 offen offset:0 lds
    buffer_load_dwordx4 v15, s[24:27], s48 offen offset:1024 lds
    buffer_load_dwordx4 v16, s[24:27], s48 offen offset:2048 lds
    buffer_load_dwordx4 v17, s[24:27], s48 offen offset:3072 lds
    s_and_b32 s59, s59, 1023
    s_waitcnt vmcnt(33)
    s_barrier
    s_mov_b32 m0, 10240
    s_nop 0
    buffer_load_dwordx4 v12, s[28:31], s58 offen offset:0 lds
    buffer_load_dwordx4 v12, s[28:31], s58 offen offset:1024 lds
    buffer_load_dwordx4 v12, s[28:31], s58 offen offset:2048 lds
    s_mov_b32 m0, 13312
    s_nop 0
    buffer_load_dwordx4 v13, s[28:31], s58 offen offset:0 lds
    buffer_load_dwordx4 v13, s[28:31], s58 offen offset:1024 lds
    buffer_load_dwordx4 v13, s[28:31], s58 offen offset:2048 lds
    s_mov_b32 m0, 16384
    s_add_u32 s58, s58, 49152
    buffer_load_dwordx4 v12, s[28:31], s58 offen offset:0 lds
    buffer_load_dwordx4 v12, s[28:31], s58 offen offset:1024 lds
    buffer_load_dwordx4 v12, s[28:31], s58 offen offset:2048 lds
    s_mov_b32 m0, 19456
    s_nop 0
    buffer_load_dwordx4 v13, s[28:31], s58 offen offset:0 lds
    buffer_load_dwordx4 v13, s[28:31], s58 offen offset:1024 lds
    buffer_load_dwordx4 v13, s[28:31], s58 offen offset:2048 lds
    s_mov_b32 m0, 22528
    s_add_u32 s58, s58, 49152
    buffer_load_dwordx4 v12, s[28:31], s58 offen offset:0 lds
    buffer_load_dwordx4 v12, s[28:31], s58 offen offset:1024 lds
    buffer_load_dwordx4 v12, s[28:31], s58 offen offset:2048 lds
    s_mov_b32 m0, 25600
    s_nop 0
    buffer_load_dwordx4 v13, s[28:31], s58 offen offset:0 lds
    buffer_load_dwordx4 v13, s[28:31], s58 offen offset:1024 lds
    buffer_load_dwordx4 v13, s[28:31], s58 offen offset:2048 lds
    s_mov_b32 m0, 28672
    s_add_u32 s58, s58, 49152
    buffer_load_dwordx4 v12, s[28:31], s58 offen offset:0 lds
    buffer_load_dwordx4 v12, s[28:31], s58 offen offset:1024 lds
    buffer_load_dwordx4 v12, s[28:31], s58 offen offset:2048 lds
    s_mov_b32 m0, 31744
    s_nop 0
    buffer_load_dwordx4 v13, s[28:31], s58 offen offset:0 lds
    buffer_load_dwordx4 v13, s[28:31], s58 offen offset:1024 lds
    buffer_load_dwordx4 v13, s[28:31], s58 offen offset:2048 lds
    s_add_u32 s58, s58, 49152
    s_cmp_eq_u32 s58, 1572864
    s_cselect_b32 s58, 0, s58
    s_mov_b32 m0, 35840
    s_add_u32 s48, s59, 65536
    buffer_load_dwordx4 v18, s[24:27], s59 offen lds
    s_mov_b32 m0, 36864
    s_nop 0
    buffer_load_dwordx4 v14, s[24:27], s59 offen offset:0 lds
    buffer_load_dwordx4 v15, s[24:27], s59 offen offset:1024 lds
    buffer_load_dwordx4 v16, s[24:27], s59 offen offset:2048 lds
    buffer_load_dwordx4 v17, s[24:27], s59 offen offset:3072 lds
    s_mov_b32 m0, 40960
    s_add_u32 s59, s59, 128
    buffer_load_dwordx4 v14, s[24:27], s48 offen offset:0 lds
    buffer_load_dwordx4 v15, s[24:27], s48 offen offset:1024 lds
    buffer_load_dwordx4 v16, s[24:27], s48 offen offset:2048 lds
    buffer_load_dwordx4 v17, s[24:27], s48 offen offset:3072 lds
    s_and_b32 s59, s59, 1023
    s_waitcnt vmcnt(33)
    s_barrier
    s_mov_b32 m0, 45056
    s_nop 0
    buffer_load_dwordx4 v12, s[28:31], s58 offen offset:0 lds
    buffer_load_dwordx4 v12, s[28:31], s58 offen offset:1024 lds
    buffer_load_dwordx4 v12, s[28:31], s58 offen offset:2048 lds
    s_mov_b32 m0, 48128
    s_nop 0
    buffer_load_dwordx4 v13, s[28:31], s58 offen offset:0 lds
    buffer_load_dwordx4 v13, s[28:31], s58 offen offset:1024 lds
    buffer_load_dwordx4 v13, s[28:31], s58 offen offset:2048 lds
    s_mov_b32 m0, 51200
    s_add_u32 s58, s58, 49152
    buffer_load_dwordx4 v12, s[28:31], s58 offen offset:0 lds
    buffer_load_dwordx4 v12, s[28:31], s58 offen offset:1024 lds
    buffer_load_dwordx4 v12, s[28:31], s58 offen offset:2048 lds
    s_mov_b32 m0, 54272
    s_nop 0
    buffer_load_dwordx4 v13, s[28:31], s58 offen offset:0 lds
    buffer_load_dwordx4 v13, s[28:31], s58 offen offset:1024 lds
    buffer_load_dwordx4 v13, s[28:31], s58 offen offset:2048 lds
    s_mov_b32 m0, 57344
    s_add_u32 s58, s58, 49152
    buffer_load_dwordx4 v12, s[28:31], s58 offen offset:0 lds
    buffer_load_dwordx4 v12, s[28:31], s58 offen offset:1024 lds
    buffer_load_dwordx4 v12, s[28:31], s58 offen offset:2048 lds
    s_mov_b32 m0, 60416
    s_nop 0
    buffer_load_dwordx4 v13, s[28:31], s58 offen offset:0 lds
    buffer_load_dwordx4 v13, s[28:31], s58 offen offset:1024 lds
    buffer_load_dwordx4 v13, s[28:31], s58 offen offset:2048 lds
    s_mov_b32 m0, 63488
    s_add_u32 s58, s58, 49152
    buffer_load_dwordx4 v12, s[28:31], s58 offen offset:0 lds
    buffer_load_dwordx4 v12, s[28:31], s58 offen offset:1024 lds
    buffer_load_dwordx4 v12, s[28:31], s58 offen offset:2048 lds
    s_mov_b32 m0, 66560
    s_nop 0
    buffer_load_dwordx4 v13, s[28:31], s58 offen offset:0 lds
    buffer_load_dwordx4 v13, s[28:31], s58 offen offset:1024 lds
    buffer_load_dwordx4 v13, s[28:31], s58 offen offset:2048 lds
    s_add_u32 s58, s58, 49152
    s_cmp_eq_u32 s58, 1572864
    s_cselect_b32 s58, 0, s58
    s_mov_b32 m0, 70656
    s_add_u32 s48, s59, 65536
    buffer_load_dwordx4 v18, s[24:27], s59 offen lds
    s_mov_b32 m0, 71680
    s_nop 0
    buffer_load_dwordx4 v14, s[24:27], s59 offen offset:0 lds
    buffer_load_dwordx4 v15, s[24:27], s59 offen offset:1024 lds
    buffer_load_dwordx4 v16, s[24:27], s59 offen offset:2048 lds
    buffer_load_dwordx4 v17, s[24:27], s59 offen offset:3072 lds
    s_mov_b32 m0, 75776
    s_add_u32 s59, s59, 128
    buffer_load_dwordx4 v14, s[24:27], s48 offen offset:0 lds
    buffer_load_dwordx4 v15, s[24:27], s48 offen offset:1024 lds
    buffer_load_dwordx4 v16, s[24:27], s48 offen offset:2048 lds
    buffer_load_dwordx4 v17, s[24:27], s48 offen offset:3072 lds
    s_and_b32 s59, s59, 1023
    s_waitcnt vmcnt(33)
    s_barrier
    s_mov_b32 m0, 79872
    s_nop 0
    buffer_load_dwordx4 v12, s[28:31], s58 offen offset:0 lds
    buffer_load_dwordx4 v12, s[28:31], s58 offen offset:1024 lds
    buffer_load_dwordx4 v12, s[28:31], s58 offen offset:2048 lds
    s_mov_b32 m0, 82944
    s_nop 0
    buffer_load_dwordx4 v13, s[28:31], s58 offen offset:0 lds
    buffer_load_dwordx4 v13, s[28:31], s58 offen offset:1024 lds
    buffer_load_dwordx4 v13, s[28:31], s58 offen offset:2048 lds
    s_mov_b32 m0, 86016
    s_add_u32 s58, s58, 49152
    buffer_load_dwordx4 v12, s[28:31], s58 offen offset:0 lds
    buffer_load_dwordx4 v12, s[28:31], s58 offen offset:1024 lds
    buffer_load_dwordx4 v12, s[28:31], s58 offen offset:2048 lds
    s_mov_b32 m0, 89088
    s_nop 0
    buffer_load_dwordx4 v13, s[28:31], s58 offen offset:0 lds
    buffer_load_dwordx4 v13, s[28:31], s58 offen offset:1024 lds
    buffer_load_dwordx4 v13, s[28:31], s58 offen offset:2048 lds
    s_mov_b32 m0, 92160
    s_add_u32 s58, s58, 49152
    buffer_load_dwordx4 v12, s[28:31], s58 offen offset:0 lds
    buffer_load_dwordx4 v12, s[28:31], s58 offen offset:1024 lds
    buffer_load_dwordx4 v12, s[28:31], s58 offen offset:2048 lds
    s_mov_b32 m0, 95232
    s_nop 0
    buffer_load_dwordx4 v13, s[28:31], s58 offen offset:0 lds
    buffer_load_dwordx4 v13, s[28:31], s58 offen offset:1024 lds
    buffer_load_dwordx4 v13, s[28:31], s58 offen offset:2048 lds
    s_mov_b32 m0, 98304
    s_add_u32 s58, s58, 49152
    buffer_load_dwordx4 v12, s[28:31], s58 offen offset:0 lds
    buffer_load_dwordx4 v12, s[28:31], s58 offen offset:1024 lds
    buffer_load_dwordx4 v12, s[28:31], s58 offen offset:2048 lds
    s_mov_b32 m0, 101376
    s_nop 0
    buffer_load_dwordx4 v13, s[28:31], s58 offen offset:0 lds
    buffer_load_dwordx4 v13, s[28:31], s58 offen offset:1024 lds
    buffer_load_dwordx4 v13, s[28:31], s58 offen offset:2048 lds
    s_add_u32 s58, s58, 49152
    s_cmp_eq_u32 s58, 1572864
    s_cselect_b32 s58, 0, s58
    s_mov_b32 m0, 105472
    s_add_u32 s48, s59, 65536
    buffer_load_dwordx4 v18, s[24:27], s59 offen lds
    s_mov_b32 m0, 106496
    s_nop 0
    buffer_load_dwordx4 v14, s[24:27], s59 offen offset:0 lds
    buffer_load_dwordx4 v15, s[24:27], s59 offen offset:1024 lds
    buffer_load_dwordx4 v16, s[24:27], s59 offen offset:2048 lds
    buffer_load_dwordx4 v17, s[24:27], s59 offen offset:3072 lds
    s_mov_b32 m0, 110592
    s_add_u32 s59, s59, 128
    buffer_load_dwordx4 v14, s[24:27], s48 offen offset:0 lds
    buffer_load_dwordx4 v15, s[24:27], s48 offen offset:1024 lds
    buffer_load_dwordx4 v16, s[24:27], s48 offen offset:2048 lds
    buffer_load_dwordx4 v17, s[24:27], s48 offen offset:3072 lds
    s_and_b32 s59, s59, 1023
    s_waitcnt vmcnt(33)
    s_barrier
    s_mov_b32 m0, 114688
    s_nop 0
    buffer_load_dwordx4 v12, s[28:31], s58 offen offset:0 lds
    buffer_load_dwordx4 v12, s[28:31], s58 offen offset:1024 lds
    buffer_load_dwordx4 v12, s[28:31], s58 offen offset:2048 lds
    s_mov_b32 m0, 117760
    s_nop 0
    buffer_load_dwordx4 v13, s[28:31], s58 offen offset:0 lds
    buffer_load_dwordx4 v13, s[28:31], s58 offen offset:1024 lds
    buffer_load_dwordx4 v13, s[28:31], s58 offen offset:2048 lds
    s_mov_b32 m0, 120832
    s_add_u32 s58, s58, 49152
    buffer_load_dwordx4 v12, s[28:31], s58 offen offset:0 lds
    buffer_load_dwordx4 v12, s[28:31], s58 offen offset:1024 lds
    buffer_load_dwordx4 v12, s[28:31], s58 offen offset:2048 lds
    s_mov_b32 m0, 123904
    s_nop 0
    buffer_load_dwordx4 v13, s[28:31], s58 offen offset:0 lds
    buffer_load_dwordx4 v13, s[28:31], s58 offen offset:1024 lds
    buffer_load_dwordx4 v13, s[28:31], s58 offen offset:2048 lds
    s_mov_b32 m0, 126976
    s_add_u32 s58, s58, 49152
    buffer_load_dwordx4 v12, s[28:31], s58 offen offset:0 lds
    buffer_load_dwordx4 v12, s[28:31], s58 offen offset:1024 lds
    buffer_load_dwordx4 v12, s[28:31], s58 offen offset:2048 lds
    s_mov_b32 m0, 130048
    s_nop 0
    buffer_load_dwordx4 v13, s[28:31], s58 offen offset:0 lds
    buffer_load_dwordx4 v13, s[28:31], s58 offen offset:1024 lds
    buffer_load_dwordx4 v13, s[28:31], s58 offen offset:2048 lds
    s_mov_b32 m0, 133120
    s_add_u32 s58, s58, 49152
    buffer_load_dwordx4 v12, s[28:31], s58 offen offset:0 lds
    buffer_load_dwordx4 v12, s[28:31], s58 offen offset:1024 lds
    buffer_load_dwordx4 v12, s[28:31], s58 offen offset:2048 lds
    s_mov_b32 m0, 136192
    s_nop 0
    buffer_load_dwordx4 v13, s[28:31], s58 offen offset:0 lds
    buffer_load_dwordx4 v13, s[28:31], s58 offen offset:1024 lds
    buffer_load_dwordx4 v13, s[28:31], s58 offen offset:2048 lds
    s_add_u32 s58, s58, 49152
    s_cmp_eq_u32 s58, 1572864
    s_cselect_b32 s58, 0, s58
    global_load_dword v6, v32, s[20:21] sc1
    s_add_u32 s48, s94, s93
    s_mov_b32 m0, 140288
    s_nop 0
    buffer_load_dwordx4 v24, s[24:27], s48 offen offset:0 lds
    buffer_load_dwordx4 v25, s[24:27], s48 offen offset:1024 lds
    buffer_load_dwordx4 v26, s[24:27], s48 offen offset:2048 lds
    buffer_load_dwordx4 v27, s[24:27], s48 offen offset:3072 lds
    s_add_u32 s48, s48, 65536
    s_mov_b32 m0, 144384
    s_nop 0
    buffer_load_dwordx4 v24, s[24:27], s48 offen offset:0 lds
    buffer_load_dwordx4 v25, s[24:27], s48 offen offset:1024 lds
    buffer_load_dwordx4 v26, s[24:27], s48 offen offset:2048 lds
    buffer_load_dwordx4 v27, s[24:27], s48 offen offset:3072 lds
    s_add_u32 s48, s48, 65536
    buffer_load_dword v7, v255, s[36:39], s95 offen
    s_mov_b32 s28, s14
    s_and_b32 s29, s15, 0xffff
    s_mov_b32 s30, 0x1c0000
    s_mov_b32 s31, 0x20000
    buffer_load_dword v7, v255, s[28:31], s95 offen
    s_waitcnt vmcnt(35)
    s_barrier
    s_lshl_b32 s48, s92, 2
    s_add_u32 s48, s48, 0
    s_and_b32 s48, s48, 15
    s_lshl_b32 m0, s48, 12
    s_lshl_b32 s48, s48, 15
    s_add_u32 s48, s48, s93
    buffer_load_dwordx4 v20, s[32:35], s48 offen offset:0 lds
    buffer_load_dwordx4 v21, s[32:35], s48 offen offset:1024 lds
    buffer_load_dwordx4 v22, s[32:35], s48 offen offset:2048 lds
    buffer_load_dwordx4 v23, s[32:35], s48 offen offset:3072 lds
    s_lshl_b32 s48, s92, 2
    s_add_u32 s48, s48, 1
    s_and_b32 s48, s48, 15
    s_lshl_b32 m0, s48, 12
    s_lshl_b32 s48, s48, 15
    s_add_u32 s48, s48, s93
    buffer_load_dwordx4 v20, s[32:35], s48 offen offset:0 lds
    buffer_load_dwordx4 v21, s[32:35], s48 offen offset:1024 lds
    buffer_load_dwordx4 v22, s[32:35], s48 offen offset:2048 lds
    buffer_load_dwordx4 v23, s[32:35], s48 offen offset:3072 lds
    s_lshl_b32 s48, s92, 2
    s_add_u32 s48, s48, 2
    s_and_b32 s48, s48, 15
    s_lshl_b32 m0, s48, 12
    s_lshl_b32 s48, s48, 15
    s_add_u32 s48, s48, s93
    buffer_load_dwordx4 v20, s[32:35], s48 offen offset:0 lds
    buffer_load_dwordx4 v21, s[32:35], s48 offen offset:1024 lds
    buffer_load_dwordx4 v22, s[32:35], s48 offen offset:2048 lds
    buffer_load_dwordx4 v23, s[32:35], s48 offen offset:3072 lds
    s_lshl_b32 s48, s92, 2
    s_add_u32 s48, s48, 3
    s_and_b32 s48, s48, 15
    s_lshl_b32 m0, s48, 12
    s_lshl_b32 s48, s48, 15
    s_add_u32 s48, s48, s93
    buffer_load_dwordx4 v20, s[32:35], s48 offen offset:0 lds
    buffer_load_dwordx4 v21, s[32:35], s48 offen offset:1024 lds
    buffer_load_dwordx4 v22, s[32:35], s48 offen offset:2048 lds
    buffer_load_dwordx4 v23, s[32:35], s48 offen offset:3072 lds
    s_waitcnt vmcnt(27)
    s_barrier
    s_waitcnt vmcnt(26)
    s_mov_b32 s49, 0x40000
NON_L:
    v_readfirstlane_b32 s46, v6
    s_nop 0
    s_cmp_lg_u32 s46, 0
    s_cbranch_scc1 NON_D
    global_load_dword v6, v32, s[20:21] sc1
    s_waitcnt vmcnt(0)
    s_sub_u32 s49, s49, 1
    s_cbranch_scc0 NON_L
    v_mov_b32 v6, 1
NON_D:
    ds_write_b32 v11, v6 offset:32
    s_lshl_b32 s48, s92, 2
    s_add_u32 s48, s48, 4
    s_and_b32 s48, s48, 15
    s_lshl_b32 m0, s48, 12
    s_lshl_b32 s48, s48, 15
    s_add_u32 s48, s48, s93
    buffer_load_dwordx4 v20, s[32:35], s48 offen offset:0 lds
    buffer_load_dwordx4 v21, s[32:35], s48 offen offset:1024 lds
    buffer_load_dwordx4 v22, s[32:35], s48 offen offset:2048 lds
    buffer_load_dwordx4 v23, s[32:35], s48 offen offset:3072 lds
    s_lshl_b32 s48, s92, 2
    s_add_u32 s48, s48, 5
    s_and_b32 s48, s48, 15
    s_lshl_b32 m0, s48, 12
    s_lshl_b32 s48, s48, 15
    s_add_u32 s48, s48, s93
    buffer_load_dwordx4 v20, s[32:35], s48 offen offset:0 lds
    buffer_load_dwordx4 v21, s[32:35], s48 offen offset:1024 lds
    buffer_load_dwordx4 v22, s[32:35], s48 offen offset:2048 lds
    buffer_load_dwordx4 v23, s[32:35], s48 offen offset:3072 lds
    s_lshl_b32 s48, s92, 2
    s_add_u32 s48, s48, 6
    s_and_b32 s48, s48, 15
    s_lshl_b32 m0, s48, 12
    s_lshl_b32 s48, s48, 15
    s_add_u32 s48, s48, s93
    buffer_load_dwordx4 v20, s[32:35], s48 offen offset:0 lds
    buffer_load_dwordx4 v21, s[32:35], s48 offen offset:1024 lds
    buffer_load_dwordx4 v22, s[32:35], s48 offen offset:2048 lds
    buffer_load_dwordx4 v23, s[32:35], s48 offen offset:3072 lds
    s_lshl_b32 s48, s92, 2
    s_add_u32 s48, s48, 7
    s_and_b32 s48, s48, 15
    s_lshl_b32 m0, s48, 12
    s_lshl_b32 s48, s48, 15
    s_add_u32 s48, s48, s93
    buffer_load_dwordx4 v20, s[32:35], s48 offen offset:0 lds
    buffer_load_dwordx4 v21, s[32:35], s48 offen offset:1024 lds
    buffer_load_dwordx4 v22, s[32:35], s48 offen offset:2048 lds
    buffer_load_dwordx4 v23, s[32:35], s48 offen offset:3072 lds
    s_lshl_b32 s48, s92, 2
    s_add_u32 s48, s48, 8
    s_and_b32 s48, s48, 15
    s_lshl_b32 m0, s48, 12
    s_lshl_b32 s48, s48, 15
    s_add_u32 s48, s48, s93
    buffer_load_dwordx4 v20, s[32:35], s48 offen offset:0 lds
    buffer_load_dwordx4 v21, s[32:35], s48 offen offset:1024 lds
    buffer_load_dwordx4 v22, s[32:35], s48 offen offset:2048 lds
    buffer_load_dwordx4 v23, s[32:35], s48 offen offset:3072 lds
    s_lshl_b32 s48, s92, 2
    s_add_u32 s48, s48, 9
    s_and_b32 s48, s48, 15
    s_lshl_b32 m0, s48, 12
    s_lshl_b32 s48, s48, 15
    s_add_u32 s48, s48, s93
    buffer_load_dwordx4 v20, s[32:35], s48 offen offset:0 lds
    buffer_load_dwordx4 v21, s[32:35], s48 offen offset:1024 lds
    buffer_load_dwordx4 v22, s[32:35], s48 offen offset:2048 lds
    buffer_load_dwordx4 v23, s[32:35], s48 offen offset:3072 lds
    s_lshl_b32 s48, s92, 2
    s_add_u32 s48, s48, 10
    s_and_b32 s48, s48, 15
    s_lshl_b32 m0, s48, 12
    s_lshl_b32 s48, s48, 15
    s_add_u32 s48, s48, s93
    buffer_load_dwordx4 v20, s[32:35], s48 offen offset:0 lds
    buffer_load_dwordx4 v21, s[32:35], s48 offen offset:1024 lds
    buffer_load_dwordx4 v22, s[32:35], s48 offen offset:2048 lds
    buffer_load_dwordx4 v23, s[32:35], s48 offen offset:3072 lds
    s_lshl_b32 s48, s92, 2
    s_add_u32 s48, s48, 11
    s_and_b32 s48, s48, 15
    s_lshl_b32 m0, s48, 12
    s_lshl_b32 s48, s48, 15
    s_add_u32 s48, s48, s93
    buffer_load_dwordx4 v20, s[32:35], s48 offen offset:0 lds
    buffer_load_dwordx4 v21, s[32:35], s48 offen offset:1024 lds
    buffer_load_dwordx4 v22, s[32:35], s48 offen offset:2048 lds
    buffer_load_dwordx4 v23, s[32:35], s48 offen offset:3072 lds
    s_lshl_b32 s48, s92, 2
    s_add_u32 s48, s48, 12
    s_and_b32 s48, s48, 15
    s_lshl_b32 m0, s48, 12
    s_lshl_b32 s48, s48, 15
    s_add_u32 s48, s48, s93
    buffer_load_dwordx4 v20, s[32:35], s48 offen offset:0 lds
    buffer_load_dwordx4 v21, s[32:35], s48 offen offset:1024 lds
    buffer_load_dwordx4 v22, s[32:35], s48 offen offset:2048 lds
    buffer_load_dwordx4 v23, s[32:35], s48 offen offset:3072 lds
    s_lshl_b32 s48, s92, 2
    s_add_u32 s48, s48, 13
    s_and_b32 s48, s48, 15
    s_lshl_b32 m0, s48, 12
    s_lshl_b32 s48, s48, 15
    s_add_u32 s48, s48, s93
    buffer_load_dwordx4 v20, s[32:35], s48 offen offset:0 lds
    buffer_load_dwordx4 v21, s[32:35], s48 offen offset:1024 lds
    buffer_load_dwordx4 v22, s[32:35], s48 offen offset:2048 lds
    buffer_load_dwordx4 v23, s[32:35], s48 offen offset:3072 lds
    s_lshl_b32 s48, s92, 2
    s_add_u32 s48, s48, 14
    s_and_b32 s48, s48, 15
    s_lshl_b32 m0, s48, 12
    s_lshl_b32 s48, s48, 15
    s_add_u32 s48, s48, s93
    buffer_load_dwordx4 v20, s[32:35], s48 offen offset:0 lds
    buffer_load_dwordx4 v21, s[32:35], s48 offen offset:1024 lds
    buffer_load_dwordx4 v22, s[32:35], s48 offen offset:2048 lds
    buffer_load_dwordx4 v23, s[32:35], s48 offen offset:3072 lds
    s_lshl_b32 s48, s92, 2
    s_add_u32 s48, s48, 15
    s_and_b32 s48, s48, 15
    s_lshl_b32 m0, s48, 12
    s_lshl_b32 s48, s48, 15
    s_add_u32 s48, s48, s93
    buffer_load_dwordx4 v20, s[32:35], s48 offen offset:0 lds
    buffer_load_dwordx4 v21, s[32:35], s48 offen offset:1024 lds
    buffer_load_dwordx4 v22, s[32:35], s48 offen offset:2048 lds
    buffer_load_dwordx4 v23, s[32:35], s48 offen offset:3072 lds
    s_waitcnt vmcnt(0)
    v_mov_b32 v4, 1
    s_mov_b64 exec, 1
    ds_add_u32 v11, v4 offset:40
    s_mov_b64 exec, -1
    s_branch P2_HELP
P1_STATS:
    s_mul_i32 s48, s45, 3072
    s_sub_u32 s48, s48, 2048
    v_add_u32 v12, s48, v2
    v_add_u32 v13, 69632, v12
    v_lshrrev_b32 v14, 3, v1
    s_mul_i32 s48, s45, 24
    s_sub_u32 s48, s48, 16
    v_add_u32 v14, s48, v14
    v_lshlrev_b32 v14, 2, v14
    v_add_u32 v14, 139264, v14
    v_mov_b32 v15, 0xffff0000
    v_mov_b32 v255, 0
    s_mov_b32 s95, 0
    v_mov_b32 v16, 0
    v_mov_b32 v17, 0
    v_mov_b32 v18, 0
    v_mov_b32 v19, 0
    v_mov_b32 v20, 0
    v_mov_b32 v21, 0
    v_mov_b32 v22, 0
    v_mov_b32 v23, 0
    v_mov_b32 v24, 0
    v_mov_b32 v25, 0
    v_mov_b32 v26, 0
    v_mov_b32 v27, 0
    v_and_b32 v5, 7, v1
    v_lshlrev_b32 v5, 2, v5
    v_add_u32 v5, 139264, v5
    ds_write2_b32 v5, v7, v7 offset0:0 offset1:80
    v_lshlrev_b32 v3, 2, v1
    v_add_u32 v3, 152576, v3
    ds_write_b32 v3, v7
    s_waitcnt lgkmcnt(0)
    s_mov_b32 s40, s22
    s_and_b32 s41, s23, 0xffff
    s_mov_b32 s42, 0x2000000
    s_mov_b32 s43, 0x20000
    s_lshr_b32 s54, s52, 0
    s_lshl_b32 s54, s54, 2
    s_lshr_b32 s55, s53, 3
    s_add_u32 s54, s54, s55
    s_and_b32 s55, s52, 0
    s_lshl_b32 s55, s55, 3
    s_and_b32 s48, s53, 7
    s_add_u32 s55, s55, s48
    s_mul_i32 s56, s53, 74
    s_lshr_b32 s56, s56, 9
    s_mul_i32 s57, s56, 7
    s_sub_u32 s57, s53, s57
    s_and_b32 s58, s52, 4
    s_add_u32 s56, s56, s58
    s_and_b32 s48, s52, 3
    s_mul_i32 s48, s48, 7
    s_add_u32 s57, s57, s48
    s_lshr_b32 s59, s52, 0
    s_lshl_b32 s59, s59, 2
    s_lshr_b32 s60, s53, 3
    s_add_u32 s59, s59, s60
    s_and_b32 s60, s52, 0
    s_lshl_b32 s60, s60, 3
    s_and_b32 s48, s53, 7
    s_add_u32 s60, s60, s48
    s_lshl_b32 s48, s54, 10
    s_add_u32 s48, s48, 14680064
    s_lshl_b32 s49, s56, 12
    s_add_u32 s49, s49, 14811136
    s_lshr_b32 s50, s59, 2
    s_lshl_b32 s50, s50, 12
    s_add_u32 s50, s50, 14942208
    s_cmp_eq_u32 s44, 6
    s_cselect_b32 s49, s49, s50
    s_cmp_eq_u32 s44, 5
    s_cselect_b32 s49, s48, s49
    s_cselect_b32 s48, 7, 31
    v_and_b32 v10, s48, v1
    v_lshlrev_b32 v10, 7, v10
    s_setprio 1
    s_barrier
    ds_read_b128 v[28:31], v12 offset:0
    ds_read_b128 v[32:35], v12 offset:1024
    ds_read_b128 v[36:39], v12 offset:2048
    s_waitcnt lgkmcnt(2)
    v_lshlrev_b32 v40, 16, v28
    v_and_b32 v52, v15, v28
    v_lshlrev_b32 v41, 16, v29
    v_and_b32 v53, v15, v29
    v_lshlrev_b32 v42, 16, v30
    v_and_b32 v54, v15, v30
    v_lshlrev_b32 v43, 16, v31
    v_and_b32 v55, v15, v31
    s_waitcnt lgkmcnt(1)
    v_lshlrev_b32 v44, 16, v32
    v_and_b32 v56, v15, v32
    v_lshlrev_b32 v45, 16, v33
    v_and_b32 v57, v15, v33
    v_lshlrev_b32 v46, 16, v34
    v_and_b32 v58, v15, v34
    v_lshlrev_b32 v47, 16, v35
    v_and_b32 v59, v15, v35
    s_waitcnt lgkmcnt(0)
    v_lshlrev_b32 v48, 16, v36
    v_and_b32 v60, v15, v36
    v_lshlrev_b32 v49, 16, v37
    v_and_b32 v61, v15, v37
    v_lshlrev_b32 v50, 16, v38
    v_and_b32 v62, v15, v38
    v_lshlrev_b32 v51, 16, v39
    v_and_b32 v63, v15, v39
    ds_read_b128 v[28:31], v12 offset:34816
    ds_read_b128 v[32:35], v12 offset:35840
    ds_read_b128 v[36:39], v12 offset:36864
    v_add_f32 v16, v16, v40
    v_add_f32 v17, v17, v52
    v_fmac_f32 v18, v40, v40
    v_fmac_f32 v19, v52, v52
    v_add_f32 v20, v20, v44
    v_add_f32 v21, v21, v56
    v_fmac_f32 v22, v44, v44
    v_fmac_f32 v23, v56, v56
    v_add_f32 v24, v24, v48
    v_add_f32 v25, v25, v60
    v_fmac_f32 v26, v48, v48
    v_fmac_f32 v27, v60, v60
    v_add_f32 v16, v16, v41
    v_add_f32 v17, v17, v53
    v_fmac_f32 v18, v41, v41
    v_fmac_f32 v19, v53, v53
    v_add_f32 v20, v20, v45
    v_add_f32 v21, v21, v57
    v_fmac_f32 v22, v45, v45
    v_fmac_f32 v23, v57, v57
    v_add_f32 v24, v24, v49
    v_add_f32 v25, v25, v61
    v_fmac_f32 v26, v49, v49
    v_fmac_f32 v27, v61, v61
    v_add_f32 v16, v16, v42
    v_add_f32 v17, v17, v54
    v_fmac_f32 v18, v42, v42
    v_fmac_f32 v19, v54, v54
    v_add_f32 v20, v20, v46
    v_add_f32 v21, v21, v58
    v_fmac_f32 v22, v46, v46
    v_fmac_f32 v23, v58, v58
    v_add_f32 v24, v24, v50
    v_add_f32 v25, v25, v62
    v_fmac_f32 v26, v50, v50
    v_fmac_f32 v27, v62, v62
    v_add_f32 v16, v16, v43
    v_add_f32 v17, v17, v55
    v_fmac_f32 v18, v43, v43
    v_fmac_f32 v19, v55, v55
    v_add_f32 v20, v20, v47
    v_add_f32 v21, v21, v59
    v_fmac_f32 v22, v47, v47
    v_fmac_f32 v23, v59, v59
    v_add_f32 v24, v24, v51
    v_add_f32 v25, v25, v63
    v_fmac_f32 v26, v51, v51
    v_fmac_f32 v27, v63, v63
    s_waitcnt lgkmcnt(2)
    v_lshlrev_b32 v40, 16, v28
    v_and_b32 v52, v15, v28
    v_lshlrev_b32 v41, 16, v29
    v_and_b32 v53, v15, v29
    v_lshlrev_b32 v42, 16, v30
    v_and_b32 v54, v15, v30
    v_lshlrev_b32 v43, 16, v31
    v_and_b32 v55, v15, v31
    s_waitcnt lgkmcnt(1)
    v_lshlrev_b32 v44, 16, v32
    v_and_b32 v56, v15, v32
    v_lshlrev_b32 v45, 16, v33
    v_and_b32 v57, v15, v33
    v_lshlrev_b32 v46, 16, v34
    v_and_b32 v58, v15, v34
    v_lshlrev_b32 v47, 16, v35
    v_and_b32 v59, v15, v35
    s_waitcnt lgkmcnt(0)
    v_lshlrev_b32 v48, 16, v36
    v_and_b32 v60, v15, v36
    v_lshlrev_b32 v49, 16, v37
    v_and_b32 v61, v15, v37
    v_lshlrev_b32 v50, 16, v38
    v_and_b32 v62, v15, v38
    v_lshlrev_b32 v51, 16, v39
    v_and_b32 v63, v15, v39
    s_barrier
    ds_read_b128 v[28:31], v13 offset:0
    ds_read_b128 v[32:35], v13 offset:1024
    ds_read_b128 v[36:39], v13 offset:2048
    v_add_f32 v16, v16, v40
    v_add_f32 v17, v17, v52
    v_fmac_f32 v18, v40, v40
    v_fmac_f32 v19, v52, v52
    v_add_f32 v20, v20, v44
    v_add_f32 v21, v21, v56
    v_fmac_f32 v22, v44, v44
    v_fmac_f32 v23, v56, v56
    v_add_f32 v24, v24, v48
    v_add_f32 v25, v25, v60
    v_fmac_f32 v26, v48, v48
    v_fmac_f32 v27, v60, v60
    v_add_f32 v16, v16, v41
    v_add_f32 v17, v17, v53
    v_fmac_f32 v18, v41, v41
    v_fmac_f32 v19, v53, v53
    v_add_f32 v20, v20, v45
    v_add_f32 v21, v21, v57
    v_fmac_f32 v22, v45, v45
    v_fmac_f32 v23, v57, v57
    v_add_f32 v24, v24, v49
    v_add_f32 v25, v25, v61
    v_fmac_f32 v26, v49, v49
    v_fmac_f32 v27, v61, v61
    v_add_f32 v16, v16, v42
    v_add_f32 v17, v17, v54
    v_fmac_f32 v18, v42, v42
    v_fmac_f32 v19, v54, v54
    v_add_f32 v20, v20, v46
    v_add_f32 v21, v21, v58
    v_fmac_f32 v22, v46, v46
    v_fmac_f32 v23, v58, v58
    v_add_f32 v24, v24, v50
    v_add_f32 v25, v25, v62
    v_fmac_f32 v26, v50, v50
    v_fmac_f32 v27, v62, v62
    v_add_f32 v16, v16, v43
    v_add_f32 v17, v17, v55
    v_fmac_f32 v18, v43, v43
    v_fmac_f32 v19, v55, v55
    v_add_f32 v20, v20, v47
    v_add_f32 v21, v21, v59
    v_fmac_f32 v22, v47, v47
    v_fmac_f32 v23, v59, v59
    v_add_f32 v24, v24, v51
    v_add_f32 v25, v25, v63
    v_fmac_f32 v26, v51, v51
    v_fmac_f32 v27, v63, v63
    s_waitcnt lgkmcnt(2)
    v_lshlrev_b32 v40, 16, v28
    v_and_b32 v52, v15, v28
    v_lshlrev_b32 v41, 16, v29
    v_and_b32 v53, v15, v29
    v_lshlrev_b32 v42, 16, v30
    v_and_b32 v54, v15, v30
    v_lshlrev_b32 v43, 16, v31
    v_and_b32 v55, v15, v31
    s_waitcnt lgkmcnt(1)
    v_lshlrev_b32 v44, 16, v32
    v_and_b32 v56, v15, v32
    v_lshlrev_b32 v45, 16, v33
    v_and_b32 v57, v15, v33
    v_lshlrev_b32 v46, 16, v34
    v_and_b32 v58, v15, v34
    v_lshlrev_b32 v47, 16, v35
    v_and_b32 v59, v15, v35
    s_waitcnt lgkmcnt(0)
    v_lshlrev_b32 v48, 16, v36
    v_and_b32 v60, v15, v36
    v_lshlrev_b32 v49, 16, v37
    v_and_b32 v61, v15, v37
    v_lshlrev_b32 v50, 16, v38
    v_and_b32 v62, v15, v38
    v_lshlrev_b32 v51, 16, v39
    v_and_b32 v63, v15, v39
    s_barrier
    ds_read_b128 v[28:31], v13 offset:34816
    ds_read_b128 v[32:35], v13 offset:35840
    ds_read_b128 v[36:39], v13 offset:36864
    v_add_f32 v16, v16, v40
    v_add_f32 v17, v17, v52
    v_fmac_f32 v18, v40, v40
    v_fmac_f32 v19, v52, v52
    v_add_f32 v20, v20, v44
    v_add_f32 v21, v21, v56
    v_fmac_f32 v22, v44, v44
    v_fmac_f32 v23, v56, v56
    v_add_f32 v24, v24, v48
    v_add_f32 v25, v25, v60
    v_fmac_f32 v26, v48, v48
    v_fmac_f32 v27, v60, v60
    v_add_f32 v16, v16, v41
    v_add_f32 v17, v17, v53
    v_fmac_f32 v18, v41, v41
    v_fmac_f32 v19, v53, v53
    v_add_f32 v20, v20, v45
    v_add_f32 v21, v21, v57
    v_fmac_f32 v22, v45, v45
    v_fmac_f32 v23, v57, v57
    v_add_f32 v24, v24, v49
    v_add_f32 v25, v25, v61
    v_fmac_f32 v26, v49, v49
    v_fmac_f32 v27, v61, v61
    v_add_f32 v16, v16, v42
    v_add_f32 v17, v17, v54
    v_fmac_f32 v18, v42, v42
    v_fmac_f32 v19, v54, v54
    v_add_f32 v20, v20, v46
    v_add_f32 v21, v21, v58
    v_fmac_f32 v22, v46, v46
    v_fmac_f32 v23, v58, v58
    v_add_f32 v24, v24, v50
    v_add_f32 v25, v25, v62
    v_fmac_f32 v26, v50, v50
    v_fmac_f32 v27, v62, v62
    v_add_f32 v16, v16, v43
    v_add_f32 v17, v17, v55
    v_fmac_f32 v18, v43, v43
    v_fmac_f32 v19, v55, v55
    v_add_f32 v20, v20, v47
    v_add_f32 v21, v21, v59
    v_fmac_f32 v22, v47, v47
    v_fmac_f32 v23, v59, v59
    v_add_f32 v24, v24, v51
    v_add_f32 v25, v25, v63
    v_fmac_f32 v26, v51, v51
    v_fmac_f32 v27, v63, v63
    s_waitcnt lgkmcnt(2)
    v_lshlrev_b32 v40, 16, v28
    v_and_b32 v52, v15, v28
    v_lshlrev_b32 v41, 16, v29
    v_and_b32 v53, v15, v29
    v_lshlrev_b32 v42, 16, v30
    v_and_b32 v54, v15, v30
    v_lshlrev_b32 v43, 16, v31
    v_and_b32 v55, v15, v31
    s_waitcnt lgkmcnt(1)
    v_lshlrev_b32 v44, 16, v32
    v_and_b32 v56, v15, v32
    v_lshlrev_b32 v45, 16, v33
    v_and_b32 v57, v15, v33
    v_lshlrev_b32 v46, 16, v34
    v_and_b32 v58, v15, v34
    v_lshlrev_b32 v47, 16, v35
    v_and_b32 v59, v15, v35
    s_waitcnt lgkmcnt(0)
    v_lshlrev_b32 v48, 16, v36
    v_and_b32 v60, v15, v36
    v_lshlrev_b32 v49, 16, v37
    v_and_b32 v61, v15, v37
    v_lshlrev_b32 v50, 16, v38
    v_and_b32 v62, v15, v38
    v_lshlrev_b32 v51, 16, v39
    v_and_b32 v63, v15, v39
    s_barrier
    ds_read_b128 v[28:31], v12 offset:0
    ds_read_b128 v[32:35], v12 offset:1024
    ds_read_b128 v[36:39], v12 offset:2048
    v_add_f32 v16, v16, v40
    v_add_f32 v17, v17, v52
    v_fmac_f32 v18, v40, v40
    v_fmac_f32 v19, v52, v52
    v_add_f32 v20, v20, v44
    v_add_f32 v21, v21, v56
    v_fmac_f32 v22, v44, v44
    v_fmac_f32 v23, v56, v56
    v_add_f32 v24, v24, v48
    v_add_f32 v25, v25, v60
    v_fmac_f32 v26, v48, v48
    v_fmac_f32 v27, v60, v60
    v_add_f32 v16, v16, v41
    v_add_f32 v17, v17, v53
    v_fmac_f32 v18, v41, v41
    v_fmac_f32 v19, v53, v53
    v_add_f32 v20, v20, v45
    v_add_f32 v21, v21, v57
    v_fmac_f32 v22, v45, v45
    v_fmac_f32 v23, v57, v57
    v_add_f32 v24, v24, v49
    v_add_f32 v25, v25, v61
    v_fmac_f32 v26, v49, v49
    v_fmac_f32 v27, v61, v61
    v_add_f32 v16, v16, v42
    v_add_f32 v17, v17, v54
    v_fmac_f32 v18, v42, v42
    v_fmac_f32 v19, v54, v54
    v_add_f32 v20, v20, v46
    v_add_f32 v21, v21, v58
    v_fmac_f32 v22, v46, v46
    v_fmac_f32 v23, v58, v58
    v_add_f32 v24, v24, v50
    v_add_f32 v25, v25, v62
    v_fmac_f32 v26, v50, v50
    v_fmac_f32 v27, v62, v62
    v_add_f32 v16, v16, v43
    v_add_f32 v17, v17, v55
    v_fmac_f32 v18, v43, v43
    v_fmac_f32 v19, v55, v55
    v_add_f32 v20, v20, v47
    v_add_f32 v21, v21, v59
    v_fmac_f32 v22, v47, v47
    v_fmac_f32 v23, v59, v59
    v_add_f32 v24, v24, v51
    v_add_f32 v25, v25, v63
    v_fmac_f32 v26, v51, v51
    v_fmac_f32 v27, v63, v63
    s_waitcnt lgkmcnt(2)
    v_lshlrev_b32 v40, 16, v28
    v_and_b32 v52, v15, v28
    v_lshlrev_b32 v41, 16, v29
    v_and_b32 v53, v15, v29
    v_lshlrev_b32 v42, 16, v30
    v_and_b32 v54, v15, v30
    v_lshlrev_b32 v43, 16, v31
    v_and_b32 v55, v15, v31
    s_waitcnt lgkmcnt(1)
    v_lshlrev_b32 v44, 16, v32
    v_and_b32 v56, v15, v32
    v_lshlrev_b32 v45, 16, v33
    v_and_b32 v57, v15, v33
    v_lshlrev_b32 v46, 16, v34
    v_and_b32 v58, v15, v34
    v_lshlrev_b32 v47, 16, v35
    v_and_b32 v59, v15, v35
    s_waitcnt lgkmcnt(0)
    v_lshlrev_b32 v48, 16, v36
    v_and_b32 v60, v15, v36
    v_lshlrev_b32 v49, 16, v37
    v_and_b32 v61, v15, v37
    v_lshlrev_b32 v50, 16, v38
    v_and_b32 v62, v15, v38
    v_lshlrev_b32 v51, 16, v39
    v_and_b32 v63, v15, v39
    s_barrier
    ds_read_b128 v[28:31], v12 offset:34816
    ds_read_b128 v[32:35], v12 offset:35840
    ds_read_b128 v[36:39], v12 offset:36864
    v_add_f32 v16, v16, v40
    v_add_f32 v17, v17, v52
    v_fmac_f32 v18, v40, v40
    v_fmac_f32 v19, v52, v52
    v_add_f32 v20, v20, v44
    v_add_f32 v21, v21, v56
    v_fmac_f32 v22, v44, v44
    v_fmac_f32 v23, v56, v56
    v_add_f32 v24, v24, v48
    v_add_f32 v25, v25, v60
    v_fmac_f32 v26, v48, v48
    v_fmac_f32 v27, v60, v60
    v_add_f32 v16, v16, v41
    v_add_f32 v17, v17, v53
    v_fmac_f32 v18, v41, v41
    v_fmac_f32 v19, v53, v53
    v_add_f32 v20, v20, v45
    v_add_f32 v21, v21, v57
    v_fmac_f32 v22, v45, v45
    v_fmac_f32 v23, v57, v57
    v_add_f32 v24, v24, v49
    v_add_f32 v25, v25, v61
    v_fmac_f32 v26, v49, v49
    v_fmac_f32 v27, v61, v61
    v_add_f32 v16, v16, v42
    v_add_f32 v17, v17, v54
    v_fmac_f32 v18, v42, v42
    v_fmac_f32 v19, v54, v54
    v_add_f32 v20, v20, v46
    v_add_f32 v21, v21, v58
    v_fmac_f32 v22, v46, v46
    v_fmac_f32 v23, v58, v58
    v_add_f32 v24, v24, v50
    v_add_f32 v25, v25, v62
    v_fmac_f32 v26, v50, v50
    v_fmac_f32 v27, v62, v62
    v_add_f32 v16, v16, v43
    v_add_f32 v17, v17, v55
    v_fmac_f32 v18, v43, v43
    v_fmac_f32 v19, v55, v55
    v_add_f32 v20, v20, v47
    v_add_f32 v21, v21, v59
    v_fmac_f32 v22, v47, v47
    v_fmac_f32 v23, v59, v59
    v_add_f32 v24, v24, v51
    v_add_f32 v25, v25, v63
    v_fmac_f32 v26, v51, v51
    v_fmac_f32 v27, v63, v63
    s_waitcnt lgkmcnt(2)
    v_lshlrev_b32 v40, 16, v28
    v_and_b32 v52, v15, v28
    v_lshlrev_b32 v41, 16, v29
    v_and_b32 v53, v15, v29
    v_lshlrev_b32 v42, 16, v30
    v_and_b32 v54, v15, v30
    v_lshlrev_b32 v43, 16, v31
    v_and_b32 v55, v15, v31
    s_waitcnt lgkmcnt(1)
    v_lshlrev_b32 v44, 16, v32
    v_and_b32 v56, v15, v32
    v_lshlrev_b32 v45, 16, v33
    v_and_b32 v57, v15, v33
    v_lshlrev_b32 v46, 16, v34
    v_and_b32 v58, v15, v34
    v_lshlrev_b32 v47, 16, v35
    v_and_b32 v59, v15, v35
    s_waitcnt lgkmcnt(0)
    v_lshlrev_b32 v48, 16, v36
    v_and_b32 v60, v15, v36
    v_lshlrev_b32 v49, 16, v37
    v_and_b32 v61, v15, v37
    v_lshlrev_b32 v50, 16, v38
    v_and_b32 v62, v15, v38
    v_lshlrev_b32 v51, 16, v39
    v_and_b32 v63, v15, v39
    s_barrier
    ds_read_b128 v[28:31], v13 offset:0
    ds_read_b128 v[32:35], v13 offset:1024
    ds_read_b128 v[36:39], v13 offset:2048
    v_add_f32 v16, v16, v40
    v_add_f32 v17, v17, v52
    v_fmac_f32 v18, v40, v40
    v_fmac_f32 v19, v52, v52
    v_add_f32 v20, v20, v44
    v_add_f32 v21, v21, v56
    v_fmac_f32 v22, v44, v44
    v_fmac_f32 v23, v56, v56
    v_add_f32 v24, v24, v48
    v_add_f32 v25, v25, v60
    v_fmac_f32 v26, v48, v48
    v_fmac_f32 v27, v60, v60
    v_add_f32 v16, v16, v41
    v_add_f32 v17, v17, v53
    v_fmac_f32 v18, v41, v41
    v_fmac_f32 v19, v53, v53
    v_add_f32 v20, v20, v45
    v_add_f32 v21, v21, v57
    v_fmac_f32 v22, v45, v45
    v_fmac_f32 v23, v57, v57
    v_add_f32 v24, v24, v49
    v_add_f32 v25, v25, v61
    v_fmac_f32 v26, v49, v49
    v_fmac_f32 v27, v61, v61
    v_add_f32 v16, v16, v42
    v_add_f32 v17, v17, v54
    v_fmac_f32 v18, v42, v42
    v_fmac_f32 v19, v54, v54
    v_add_f32 v20, v20, v46
    v_add_f32 v21, v21, v58
    v_fmac_f32 v22, v46, v46
    v_fmac_f32 v23, v58, v58
    v_add_f32 v24, v24, v50
    v_add_f32 v25, v25, v62
    v_fmac_f32 v26, v50, v50
    v_fmac_f32 v27, v62, v62
    v_add_f32 v16, v16, v43
    v_add_f32 v17, v17, v55
    v_fmac_f32 v18, v43, v43
    v_fmac_f32 v19, v55, v55
    v_add_f32 v20, v20, v47
    v_add_f32 v21, v21, v59
    v_fmac_f32 v22, v47, v47
    v_fmac_f32 v23, v59, v59
    v_add_f32 v24, v24, v51
    v_add_f32 v25, v25, v63
    v_fmac_f32 v26, v51, v51
    v_fmac_f32 v27, v63, v63
    s_waitcnt lgkmcnt(2)
    v_lshlrev_b32 v40, 16, v28
    v_and_b32 v52, v15, v28
    v_lshlrev_b32 v41, 16, v29
    v_and_b32 v53, v15, v29
    v_lshlrev_b32 v42, 16, v30
    v_and_b32 v54, v15, v30
    v_lshlrev_b32 v43, 16, v31
    v_and_b32 v55, v15, v31
    s_waitcnt lgkmcnt(1)
    v_lshlrev_b32 v44, 16, v32
    v_and_b32 v56, v15, v32
    v_lshlrev_b32 v45, 16, v33
    v_and_b32 v57, v15, v33
    v_lshlrev_b32 v46, 16, v34
    v_and_b32 v58, v15, v34
    v_lshlrev_b32 v47, 16, v35
    v_and_b32 v59, v15, v35
    s_waitcnt lgkmcnt(0)
    v_lshlrev_b32 v48, 16, v36
    v_and_b32 v60, v15, v36
    v_lshlrev_b32 v49, 16, v37
    v_and_b32 v61, v15, v37
    v_lshlrev_b32 v50, 16, v38
    v_and_b32 v62, v15, v38
    v_lshlrev_b32 v51, 16, v39
    v_and_b32 v63, v15, v39
    s_barrier
    ds_read_b128 v[28:31], v13 offset:34816
    ds_read_b128 v[32:35], v13 offset:35840
    ds_read_b128 v[36:39], v13 offset:36864
    v_add_f32 v16, v16, v40
    v_add_f32 v17, v17, v52
    v_fmac_f32 v18, v40, v40
    v_fmac_f32 v19, v52, v52
    v_add_f32 v20, v20, v44
    v_add_f32 v21, v21, v56
    v_fmac_f32 v22, v44, v44
    v_fmac_f32 v23, v56, v56
    v_add_f32 v24, v24, v48
    v_add_f32 v25, v25, v60
    v_fmac_f32 v26, v48, v48
    v_fmac_f32 v27, v60, v60
    v_add_f32 v16, v16, v41
    v_add_f32 v17, v17, v53
    v_fmac_f32 v18, v41, v41
    v_fmac_f32 v19, v53, v53
    v_add_f32 v20, v20, v45
    v_add_f32 v21, v21, v57
    v_fmac_f32 v22, v45, v45
    v_fmac_f32 v23, v57, v57
    v_add_f32 v24, v24, v49
    v_add_f32 v25, v25, v61
    v_fmac_f32 v26, v49, v49
    v_fmac_f32 v27, v61, v61
    v_add_f32 v16, v16, v42
    v_add_f32 v17, v17, v54
    v_fmac_f32 v18, v42, v42
    v_fmac_f32 v19, v54, v54
    v_add_f32 v20, v20, v46
    v_add_f32 v21, v21, v58
    v_fmac_f32 v22, v46, v46
    v_fmac_f32 v23, v58, v58
    v_add_f32 v24, v24, v50
    v_add_f32 v25, v25, v62
    v_fmac_f32 v26, v50, v50
    v_fmac_f32 v27, v62, v62
    v_add_f32 v16, v16, v43
    v_add_f32 v17, v17, v55
    v_fmac_f32 v18, v43, v43
    v_fmac_f32 v19, v55, v55
    v_add_f32 v20, v20, v47
    v_add_f32 v21, v21, v59
    v_fmac_f32 v22, v47, v47
    v_fmac_f32 v23, v59, v59
    v_add_f32 v24, v24, v51
    v_add_f32 v25, v25, v63
    v_fmac_f32 v26, v51, v51
    v_fmac_f32 v27, v63, v63
    s_waitcnt lgkmcnt(2)
    v_lshlrev_b32 v40, 16, v28
    v_and_b32 v52, v15, v28
    v_lshlrev_b32 v41, 16, v29
    v_and_b32 v53, v15, v29
    v_lshlrev_b32 v42, 16, v30
    v_and_b32 v54, v15, v30
    v_lshlrev_b32 v43, 16, v31
    v_and_b32 v55, v15, v31
    s_waitcnt lgkmcnt(1)
    v_lshlrev_b32 v44, 16, v32
    v_and_b32 v56, v15, v32
    v_lshlrev_b32 v45, 16, v33
    v_and_b32 v57, v15, v33
    v_lshlrev_b32 v46, 16, v34
    v_and_b32 v58, v15, v34
    v_lshlrev_b32 v47, 16, v35
    v_and_b32 v59, v15, v35
    s_waitcnt lgkmcnt(0)
    v_lshlrev_b32 v48, 16, v36
    v_and_b32 v60, v15, v36
    v_lshlrev_b32 v49, 16, v37
    v_and_b32 v61, v15, v37
    v_lshlrev_b32 v50, 16, v38
    v_and_b32 v62, v15, v38
    v_lshlrev_b32 v51, 16, v39
    v_and_b32 v63, v15, v39
    s_barrier
    buffer_load_dword v9, v10, s[40:43], s49 offen sc1
    v_add_f32 v16, v16, v40
    v_add_f32 v17, v17, v52
    v_fmac_f32 v18, v40, v40
    v_fmac_f32 v19, v52, v52
    v_add_f32 v20, v20, v44
    v_add_f32 v21, v21, v56
    v_fmac_f32 v22, v44, v44
    v_fmac_f32 v23, v56, v56
    v_add_f32 v24, v24, v48
    v_add_f32 v25, v25, v60
    v_fmac_f32 v26, v48, v48
    v_fmac_f32 v27, v60, v60
    v_add_f32 v16, v16, v41
    v_add_f32 v17, v17, v53
    v_fmac_f32 v18, v41, v41
    v_fmac_f32 v19, v53, v53
    v_add_f32 v20, v20, v45
    v_add_f32 v21, v21, v57
    v_fmac_f32 v22, v45, v45
    v_fmac_f32 v23, v57, v57
    v_add_f32 v24, v24, v49
    v_add_f32 v25, v25, v61
    v_fmac_f32 v26, v49, v49
    v_fmac_f32 v27, v61, v61
    v_add_f32 v16, v16, v42
    v_add_f32 v17, v17, v54
    v_fmac_f32 v18, v42, v42
    v_fmac_f32 v19, v54, v54
    v_add_f32 v20, v20, v46
    v_add_f32 v21, v21, v58
    v_fmac_f32 v22, v46, v46
    v_fmac_f32 v23, v58, v58
    v_add_f32 v24, v24, v50
    v_add_f32 v25, v25, v62
    v_fmac_f32 v26, v50, v50
    v_fmac_f32 v27, v62, v62
    v_add_f32 v16, v16, v43
    v_add_f32 v17, v17, v55
    v_fmac_f32 v18, v43, v43
    v_fmac_f32 v19, v55, v55
    v_add_f32 v20, v20, v47
    v_add_f32 v21, v21, v59
    v_fmac_f32 v22, v47, v47
    v_fmac_f32 v23, v59, v59
    v_add_f32 v24, v24, v51
    v_add_f32 v25, v25, v63
    v_fmac_f32 v26, v51, v51
    v_fmac_f32 v27, v63, v63
    v_add_f32 v16, v16, v17
    v_add_f32 v18, v18, v19
    v_add_f32 v20, v20, v21
    v_add_f32 v22, v22, v23
    v_add_f32 v24, v24, v25
    v_add_f32 v26, v26, v27
    v_add_f32_dpp v16, v16, v16 quad_perm:[1,0,3,2] row_mask:0xf bank_mask:0xf
    v_add_f32_dpp v18, v18, v18 quad_perm:[1,0,3,2] row_mask:0xf bank_mask:0xf
    v_add_f32_dpp v20, v20, v20 quad_perm:[1,0,3,2] row_mask:0xf bank_mask:0xf
    v_add_f32_dpp v22, v22, v22 quad_perm:[1,0,3,2] row_mask:0xf bank_mask:0xf
    v_add_f32_dpp v24, v24, v24 quad_perm:[1,0,3,2] row_mask:0xf bank_mask:0xf
    v_add_f32_dpp v26, v26, v26 quad_perm:[1,0,3,2] row_mask:0xf bank_mask:0xf
    v_add_f32_dpp v16, v16, v16 quad_perm:[2,3,0,1] row_mask:0xf bank_mask:0xf
    v_add_f32_dpp v18, v18, v18 quad_perm:[2,3,0,1] row_mask:0xf bank_mask:0xf
    v_add_f32_dpp v20, v20, v20 quad_perm:[2,3,0,1] row_mask:0xf bank_mask:0xf
    v_add_f32_dpp v22, v22, v22 quad_perm:[2,3,0,1] row_mask:0xf bank_mask:0xf
    v_add_f32_dpp v24, v24, v24 quad_perm:[2,3,0,1] row_mask:0xf bank_mask:0xf
    v_add_f32_dpp v26, v26, v26 quad_perm:[2,3,0,1] row_mask:0xf bank_mask:0xf
    v_add_f32_dpp v16, v16, v16 row_half_mirror row_mask:0xf bank_mask:0xf
    v_add_f32_dpp v18, v18, v18 row_half_mirror row_mask:0xf bank_mask:0xf
    v_add_f32_dpp v20, v20, v20 row_half_mirror row_mask:0xf bank_mask:0xf
    v_add_f32_dpp v22, v22, v22 row_half_mirror row_mask:0xf bank_mask:0xf
    v_add_f32_dpp v24, v24, v24 row_half_mirror row_mask:0xf bank_mask:0xf
    v_add_f32_dpp v26, v26, v26 row_half_mirror row_mask:0xf bank_mask:0xf
    v_mul_f32 v16, 0x3b000000, v16
    v_mul_f32 v20, 0x3b000000, v20
    v_mul_f32 v24, 0x3b000000, v24
    v_mul_f32 v18, 0x3b000000, v18
    v_mul_f32 v22, 0x3b000000, v22
    v_mul_f32 v26, 0x3b000000, v26
    v_fma_f32 v18, -v16, v16, v18
    v_fma_f32 v22, -v20, v20, v22
    v_fma_f32 v26, -v24, v24, v26
    v_max_f32 v18, 0, v18
    v_max_f32 v22, 0, v22
    v_max_f32 v26, 0, v26
    v_add_f32 v18, 0x3727c5ac, v18
    v_add_f32 v22, 0x3727c5ac, v22
    v_add_f32 v26, 0x3727c5ac, v26
    v_rsq_f32 v18, v18
    v_rsq_f32 v22, v22
    v_rsq_f32 v26, v26
    ds_write2_b32 v14, v16, v18 offset0:0 offset1:80
    ds_write2_b32 v14, v20, v22 offset0:8 offset1:88
    ds_write2_b32 v14, v24, v26 offset0:16 offset1:96
    v_mov_b32 v4, 1
    s_mov_b64 exec, 1
    ds_add_u32 v11, v4 offset:36
    s_mov_b64 exec, -1
    s_setprio 0
P2_HELP:
    s_mul_i32 s58, s53, 74
    s_lshr_b32 s58, s58, 9
    s_mul_i32 s59, s58, 7
    s_sub_u32 s59, s53, s59
    s_and_b32 s60, s52, 4
    s_add_u32 s58, s58, s60
    s_and_b32 s48, s52, 3
    s_mul_i32 s48, s48, 7
    s_add_u32 s59, s59, s48
    s_mov_b32 s36, s12
    s_and_b32 s37, s13, 0xffff
    s_mov_b32 s38, 0x1c0000
    s_mov_b32 s39, 0x20000
    s_mov_b32 s28, s14
    s_and_b32 s29, s15, 0xffff
    s_mov_b32 s30, 0x1c0000
    s_mov_b32 s31, 0x20000
    v_lshrrev_b32 v3, 3, v1
    v_and_b32 v4, 2, v3
    v_lshlrev_b32 v4, 1, v4
    v_and_b32 v12, 7, v1
    v_xor_b32 v12, v12, v4
    v_lshlrev_b32 v12, 4, v12
    v_xor_b32 v14, 32, v12
    v_mul_u32_u24 v3, 3584, v3
    s_lshl_b32 s49, s59, 7
    v_add_u32 v3, s49, v3
    v_add_u32 v12, v12, v3
    v_add_u32 v14, v14, v3
    v_add_u32 v13, 27648, v12
    v_add_u32 v15, 27648, v14
    v_bfe_u32 v3, v1, 3, 1
    v_lshlrev_b32 v3, 1, v3
    v_bfe_u32 v4, v1, 4, 1
    v_xor_b32 v3, v3, v4
    v_lshlrev_b32 v16, 5, v3
    v_lshl_add_u32 v16, v4, 13, v16
    v_and_b32 v3, 1, v1
    v_lshl_add_u32 v16, v3, 4, v16
    v_bfe_u32 v3, v1, 1, 1
    v_lshl_add_u32 v16, v3, 3, v16
    v_bfe_u32 v3, v1, 2, 2
    v_lshl_add_u32 v16, v3, 7, v16
    v_lshrrev_b32 v3, 5, v1
    v_lshl_add_u32 v16, v3, 10, v16
    s_lshl_b32 s49, s45, 14
    s_add_u32 s49, s49, 65536
    v_add_u32 v16, s49, v16
    v_add_u32 v20, s49, v2
    v_xor_b32 v17, 32, v16
    v_xor_b32 v18, 64, v16
    v_xor_b32 v19, 96, v16
    v_mov_b32 v24, 0
    v_mov_b32 v25, 0
    v_mov_b32 v26, 0
    v_mov_b32 v27, 0
    s_cmp_ge_u32 s53, 28
    s_cbranch_scc1 P3_START
    s_mov_b32 s61, 0
    s_lshl_b32 s62, s45, 14
    s_add_u32 s62, s62, 65536
LW_12:
    ds_read_b32 v5, v11 offset:0
    s_waitcnt lgkmcnt(0)
    v_readfirstlane_b32 s48, v5
    s_nop 0
    s_cmp_lt_u32 s48, 4
    s_sleep 1
    s_cbranch_scc1 LW_12
    s_setprio 0
P2_HL:
    s_xor_b32 s48, s60, s45
    s_xor_b32 s48, s48, s61
    s_mul_i32 s48, s48, 229376
    s_add_u32 s50, s58, 0
    s_and_b32 s50, s50, 3
    s_mul_i32 s51, s50, 57344
    s_add_u32 s51, s51, s48
    s_lshl_b32 s50, s50, 11
    s_add_u32 s50, s50, s62
    s_add_u32 m0, s50, 0
    s_nop 0
    buffer_load_dwordx4 v12, s[36:39], s51 offen offset:0 lds
    buffer_load_dwordx4 v13, s[36:39], s51 offen offset:1024 lds
    s_add_u32 m0, s50, 8192
    s_nop 0
    buffer_load_dwordx4 v14, s[28:31], s51 offen offset:0 lds
    buffer_load_dwordx4 v15, s[28:31], s51 offen offset:1024 lds
    s_add_u32 s50, s58, 1
    s_and_b32 s50, s50, 3
    s_mul_i32 s51, s50, 57344
    s_add_u32 s51, s51, s48
    s_lshl_b32 s50, s50, 11
    s_add_u32 s50, s50, s62
    s_add_u32 m0, s50, 0
    s_nop 0
    buffer_load_dwordx4 v12, s[36:39], s51 offen offset:0 lds
    buffer_load_dwordx4 v13, s[36:39], s51 offen offset:1024 lds
    s_add_u32 m0, s50, 8192
    s_nop 0
    buffer_load_dwordx4 v14, s[28:31], s51 offen offset:0 lds
    buffer_load_dwordx4 v15, s[28:31], s51 offen offset:1024 lds
    s_add_u32 s50, s58, 2
    s_and_b32 s50, s50, 3
    s_mul_i32 s51, s50, 57344
    s_add_u32 s51, s51, s48
    s_lshl_b32 s50, s50, 11
    s_add_u32 s50, s50, s62
    s_add_u32 m0, s50, 0
    s_nop 0
    buffer_load_dwordx4 v12, s[36:39], s51 offen offset:0 lds
    buffer_load_dwordx4 v13, s[36:39], s51 offen offset:1024 lds
    s_add_u32 m0, s50, 8192
    s_nop 0
    buffer_load_dwordx4 v14, s[28:31], s51 offen offset:0 lds
    buffer_load_dwordx4 v15, s[28:31], s51 offen offset:1024 lds
    s_add_u32 s50, s58, 3
    s_and_b32 s50, s50, 3
    s_mul_i32 s51, s50, 57344
    s_add_u32 s51, s51, s48
    s_lshl_b32 s50, s50, 11
    s_add_u32 s50, s50, s62
    s_add_u32 m0, s50, 0
    s_nop 0
    buffer_load_dwordx4 v12, s[36:39], s51 offen offset:0 lds
    buffer_load_dwordx4 v13, s[36:39], s51 offen offset:1024 lds
    s_add_u32 m0, s50, 8192
    s_nop 0
    buffer_load_dwordx4 v14, s[28:31], s51 offen offset:0 lds
    buffer_load_dwordx4 v15, s[28:31], s51 offen offset:1024 lds
    s_cmp_lg_u32 s61, 0
    s_cbranch_scc1 P2_HD
    s_mov_b32 s61, 4
    s_sub_u32 s62, s62, 65536
    s_branch LE_14
LW_13:
    s_sleep 1
LE_14:
    ds_read_b32 v5, v11 offset:44
    s_waitcnt lgkmcnt(0)
    v_readfirstlane_b32 s48, v5
    s_nop 0
    s_cmp_lt_u32 s48, 4
    s_cbranch_scc1 LW_13
    s_branch LE_16
LW_15:
    s_sleep 1
LE_16:
    ds_read_b32 v5, v11 offset:60
    s_waitcnt lgkmcnt(0)
    v_readfirstlane_b32 s48, v5
    s_nop 0
    s_cmp_lt_u32 s48, 4
    s_cbranch_scc1 LW_15
    s_branch P2_HL
P2_HD:
    s_waitcnt vmcnt(0)
    ds_read_b64_tr_b16 v[28:29], v16 offset:0
    ds_read_b64_tr_b16 v[30:31], v16 offset:512
    ds_read_b64_tr_b16 v[32:33], v17 offset:0
    ds_read_b64_tr_b16 v[34:35], v17 offset:512
    ds_read_b64_tr_b16 v[36:37], v18 offset:0
    ds_read_b64_tr_b16 v[38:39], v18 offset:512
    ds_read_b64_tr_b16 v[40:41], v19 offset:0
    ds_read_b64_tr_b16 v[42:43], v19 offset:512
    ds_read_b64_tr_b16 v[44:45], v16 offset:2048
    ds_read_b64_tr_b16 v[46:47], v16 offset:2560
    ds_read_b64_tr_b16 v[48:49], v17 offset:2048
    ds_read_b64_tr_b16 v[50:51], v17 offset:2560
    ds_read_b64_tr_b16 v[52:53], v18 offset:2048
    ds_read_b64_tr_b16 v[54:55], v18 offset:2560
    ds_read_b64_tr_b16 v[56:57], v19 offset:2048
    ds_read_b64_tr_b16 v[58:59], v19 offset:2560
    ds_read_b64_tr_b16 v[60:61], v16 offset:4096
    ds_read_b64_tr_b16 v[62:63], v16 offset:4608
    ds_read_b64_tr_b16 v[64:65], v17 offset:4096
    ds_read_b64_tr_b16 v[66:67], v17 offset:4608
    ds_read_b64_tr_b16 v[68:69], v18 offset:4096
    ds_read_b64_tr_b16 v[70:71], v18 offset:4608
    ds_read_b64_tr_b16 v[72:73], v19 offset:4096
    ds_read_b64_tr_b16 v[74:75], v19 offset:4608
    ds_read_b64_tr_b16 v[76:77], v16 offset:6144
    ds_read_b64_tr_b16 v[78:79], v16 offset:6656
    ds_read_b64_tr_b16 v[80:81], v17 offset:6144
    ds_read_b64_tr_b16 v[82:83], v17 offset:6656
    ds_read_b64_tr_b16 v[84:85], v18 offset:6144
    ds_read_b64_tr_b16 v[86:87], v18 offset:6656
    ds_read_b64_tr_b16 v[88:89], v19 offset:6144
    ds_read_b64_tr_b16 v[90:91], v19 offset:6656
    v_subrev_u32 v16, 65536, v16
    v_subrev_u32 v17, 65536, v17
    v_subrev_u32 v18, 65536, v18
    v_subrev_u32 v19, 65536, v19
    ds_read_b64_tr_b16 v[92:93], v16 offset:0
    ds_read_b64_tr_b16 v[94:95], v16 offset:512
    ds_read_b64_tr_b16 v[96:97], v17 offset:0
    ds_read_b64_tr_b16 v[98:99], v17 offset:512
    ds_read_b64_tr_b16 v[100:101], v18 offset:0
    ds_read_b64_tr_b16 v[102:103], v18 offset:512
    ds_read_b64_tr_b16 v[104:105], v19 offset:0
    ds_read_b64_tr_b16 v[106:107], v19 offset:512
    ds_read_b64_tr_b16 v[108:109], v16 offset:2048
    ds_read_b64_tr_b16 v[110:111], v16 offset:2560
    ds_read_b64_tr_b16 v[112:113], v17 offset:2048
    ds_read_b64_tr_b16 v[114:115], v17 offset:2560
    ds_read_b64_tr_b16 v[116:117], v18 offset:2048
    ds_read_b64_tr_b16 v[118:119], v18 offset:2560
    ds_read_b64_tr_b16 v[120:121], v19 offset:2048
    ds_read_b64_tr_b16 v[122:123], v19 offset:2560
    ds_read_b64_tr_b16 v[124:125], v16 offset:4096
    ds_read_b64_tr_b16 v[126:127], v16 offset:4608
    ds_read_b64_tr_b16 v[128:129], v17 offset:4096
    ds_read_b64_tr_b16 v[130:131], v17 offset:4608
    ds_read_b64_tr_b16 v[132:133], v18 offset:4096
    ds_read_b64_tr_b16 v[134:135], v18 offset:4608
    ds_read_b64_tr_b16 v[136:137], v19 offset:4096
    ds_read_b64_tr_b16 v[138:139], v19 offset:4608
    ds_read_b64_tr_b16 v[140:141], v16 offset:6144
    ds_read_b64_tr_b16 v[142:143], v16 offset:6656
    ds_read_b64_tr_b16 v[144:145], v17 offset:6144
    ds_read_b64_tr_b16 v[146:147], v17 offset:6656
    ds_read_b64_tr_b16 v[148:149], v18 offset:6144
    ds_read_b64_tr_b16 v[150:151], v18 offset:6656
    ds_read_b64_tr_b16 v[152:153], v19 offset:6144
    ds_read_b64_tr_b16 v[154:155], v19 offset:6656
    s_lshl_b32 s48, s45, 2
    v_add_u32 v20, s48, v11
LW_17:
    ds_read_b32 v5, v20 offset:16
    s_waitcnt lgkmcnt(0)
    v_readfirstlane_b32 s48, v5
    s_nop 0
    s_cmp_eq_u32 s48, 0
    s_sleep 1
    s_cbranch_scc1 LW_17
    v_dot2c_f32_bf16 v24, s47, v28
    v_dot2c_f32_bf16 v25, s47, v32
    v_dot2c_f32_bf16 v26, s47, v36
    v_dot2c_f32_bf16 v27, s47, v40
    v_dot2c_f32_bf16 v24, s47, v29
    v_dot2c_f32_bf16 v25, s47, v33
    v_dot2c_f32_bf16 v26, s47, v37
    v_dot2c_f32_bf16 v27, s47, v41
    v_dot2c_f32_bf16 v24, s47, v30
    v_dot2c_f32_bf16 v25, s47, v34
    v_dot2c_f32_bf16 v26, s47, v38
    v_dot2c_f32_bf16 v27, s47, v42
    v_dot2c_f32_bf16 v24, s47, v31
    v_dot2c_f32_bf16 v25, s47, v35
    v_dot2c_f32_bf16 v26, s47, v39
    v_dot2c_f32_bf16 v27, s47, v43
    v_dot2c_f32_bf16 v24, s47, v44
    v_dot2c_f32_bf16 v25, s47, v48
    v_dot2c_f32_bf16 v26, s47, v52
    v_dot2c_f32_bf16 v27, s47, v56
    v_dot2c_f32_bf16 v24, s47, v45
    v_dot2c_f32_bf16 v25, s47, v49
    v_dot2c_f32_bf16 v26, s47, v53
    v_dot2c_f32_bf16 v27, s47, v57
    v_dot2c_f32_bf16 v24, s47, v46
    v_dot2c_f32_bf16 v25, s47, v50
    v_dot2c_f32_bf16 v26, s47, v54
    v_dot2c_f32_bf16 v27, s47, v58
    v_dot2c_f32_bf16 v24, s47, v47
    v_dot2c_f32_bf16 v25, s47, v51
    v_dot2c_f32_bf16 v26, s47, v55
    v_dot2c_f32_bf16 v27, s47, v59
    v_dot2c_f32_bf16 v24, s47, v60
    v_dot2c_f32_bf16 v25, s47, v64
    v_dot2c_f32_bf16 v26, s47, v68
    v_dot2c_f32_bf16 v27, s47, v72
    v_dot2c_f32_bf16 v24, s47, v61
    v_dot2c_f32_bf16 v25, s47, v65
    v_dot2c_f32_bf16 v26, s47, v69
    v_dot2c_f32_bf16 v27, s47, v73
    v_dot2c_f32_bf16 v24, s47, v62
    v_dot2c_f32_bf16 v25, s47, v66
    v_dot2c_f32_bf16 v26, s47, v70
    v_dot2c_f32_bf16 v27, s47, v74
    v_dot2c_f32_bf16 v24, s47, v63
    v_dot2c_f32_bf16 v25, s47, v67
    v_dot2c_f32_bf16 v26, s47, v71
    v_dot2c_f32_bf16 v27, s47, v75
    v_dot2c_f32_bf16 v24, s47, v76
    v_dot2c_f32_bf16 v25, s47, v80
    v_dot2c_f32_bf16 v26, s47, v84
    v_dot2c_f32_bf16 v27, s47, v88
    v_dot2c_f32_bf16 v24, s47, v77
    v_dot2c_f32_bf16 v25, s47, v81
    v_dot2c_f32_bf16 v26, s47, v85
    v_dot2c_f32_bf16 v27, s47, v89
    v_dot2c_f32_bf16 v24, s47, v78
    v_dot2c_f32_bf16 v25, s47, v82
    v_dot2c_f32_bf16 v26, s47, v86
    v_dot2c_f32_bf16 v27, s47, v90
    v_dot2c_f32_bf16 v24, s47, v79
    v_dot2c_f32_bf16 v25, s47, v83
    v_dot2c_f32_bf16 v26, s47, v87
    v_dot2c_f32_bf16 v27, s47, v91
    v_dot2c_f32_bf16 v24, s47, v92
    v_dot2c_f32_bf16 v25, s47, v96
    v_dot2c_f32_bf16 v26, s47, v100
    v_dot2c_f32_bf16 v27, s47, v104
    v_dot2c_f32_bf16 v24, s47, v93
    v_dot2c_f32_bf16 v25, s47, v97
    v_dot2c_f32_bf16 v26, s47, v101
    v_dot2c_f32_bf16 v27, s47, v105
    v_dot2c_f32_bf16 v24, s47, v94
    v_dot2c_f32_bf16 v25, s47, v98
    v_dot2c_f32_bf16 v26, s47, v102
    v_dot2c_f32_bf16 v27, s47, v106
    v_dot2c_f32_bf16 v24, s47, v95
    v_dot2c_f32_bf16 v25, s47, v99
    v_dot2c_f32_bf16 v26, s47, v103
    v_dot2c_f32_bf16 v27, s47, v107
    v_dot2c_f32_bf16 v24, s47, v108
    v_dot2c_f32_bf16 v25, s47, v112
    v_dot2c_f32_bf16 v26, s47, v116
    v_dot2c_f32_bf16 v27, s47, v120
    v_dot2c_f32_bf16 v24, s47, v109
    v_dot2c_f32_bf16 v25, s47, v113
    v_dot2c_f32_bf16 v26, s47, v117
    v_dot2c_f32_bf16 v27, s47, v121
    v_dot2c_f32_bf16 v24, s47, v110
    v_dot2c_f32_bf16 v25, s47, v114
    v_dot2c_f32_bf16 v26, s47, v118
    v_dot2c_f32_bf16 v27, s47, v122
    v_dot2c_f32_bf16 v24, s47, v111
    v_dot2c_f32_bf16 v25, s47, v115
    v_dot2c_f32_bf16 v26, s47, v119
    v_dot2c_f32_bf16 v27, s47, v123
    v_dot2c_f32_bf16 v24, s47, v124
    v_dot2c_f32_bf16 v25, s47, v128
    v_dot2c_f32_bf16 v26, s47, v132
    v_dot2c_f32_bf16 v27, s47, v136
    v_dot2c_f32_bf16 v24, s47, v125
    v_dot2c_f32_bf16 v25, s47, v129
    v_dot2c_f32_bf16 v26, s47, v133
    v_dot2c_f32_bf16 v27, s47, v137
    v_dot2c_f32_bf16 v24, s47, v126
    v_dot2c_f32_bf16 v25, s47, v130
    v_dot2c_f32_bf16 v26, s47, v134
    v_dot2c_f32_bf16 v27, s47, v138
    v_dot2c_f32_bf16 v24, s47, v127
    v_dot2c_f32_bf16 v25, s47, v131
    v_dot2c_f32_bf16 v26, s47, v135
    v_dot2c_f32_bf16 v27, s47, v139
    v_dot2c_f32_bf16 v24, s47, v140
    v_dot2c_f32_bf16 v25, s47, v144
    v_dot2c_f32_bf16 v26, s47, v148
    v_dot2c_f32_bf16 v27, s47, v152
    v_dot2c_f32_bf16 v24, s47, v141
    v_dot2c_f32_bf16 v25, s47, v145
    v_dot2c_f32_bf16 v26, s47, v149
    v_dot2c_f32_bf16 v27, s47, v153
    v_dot2c_f32_bf16 v24, s47, v142
    v_dot2c_f32_bf16 v25, s47, v146
    v_dot2c_f32_bf16 v26, s47, v150
    v_dot2c_f32_bf16 v27, s47, v154
    v_dot2c_f32_bf16 v24, s47, v143
    v_dot2c_f32_bf16 v25, s47, v147
    v_dot2c_f32_bf16 v26, s47, v151
    v_dot2c_f32_bf16 v27, s47, v155
    v_mov_b32 v28, v24
    v_mov_b32 v29, v25
    v_mov_b32 v30, v26
    v_mov_b32 v31, v27
    v_permlane32_swap_b32 v28, v24
    v_permlane32_swap_b32 v29, v25
    v_permlane32_swap_b32 v30, v26
    v_permlane32_swap_b32 v31, v27
    v_add_f32 v24, v24, v28
    v_add_f32 v25, v25, v29
    v_add_f32 v26, v26, v30
    v_add_f32 v27, v27, v31
    s_lshl_b32 s48, s45, 10
    s_add_u32 s48, s48, 148480
    v_add_u32 v3, s48, v2
    ds_write_b128 v3, v[24:27]
    s_setprio 0
P3_START:
    s_lshr_b32 s92, s52, 0
    s_lshl_b32 s92, s92, 2
    s_lshr_b32 s93, s53, 3
    s_add_u32 s92, s92, s93
    s_and_b32 s93, s52, 0
    s_lshl_b32 s93, s93, 3
    s_and_b32 s48, s53, 7
    s_add_u32 s93, s93, s48
    s_mov_b32 s24, s16
    s_and_b32 s25, s17, 0xffff
    s_mov_b32 s26, 0x1c0000
    s_mov_b32 s27, 0x20000
    s_add_u32 s91, s92, s93
    s_and_b32 s91, s91, 1
    s_lshl_b32 s95, s91, 15
    s_mov_b32 s95, 0
    s_mul_i32 s91, s91, 0
    v_lshrrev_b32 v3, 3, v1
    v_and_b32 v4, 2, v3
    v_lshlrev_b32 v4, 1, v4
    v_and_b32 v12, 7, v1
    v_xor_b32 v12, v12, v4
    v_lshlrev_b32 v12, 4, v12
    v_lshl_add_u32 v12, v3, 10, v12
    v_add_u32 v13, 7168, v12
    v_add_u32 v14, 14336, v12
    v_add_u32 v15, 21504, v12
    s_lshr_b32 s50, s45, 1
    s_and_b32 s51, s45, 1
    s_mul_i32 s48, s50, 917504
    s_lshl_b32 s49, s51, 16
    s_add_u32 s48, s48, s49
    s_lshl_b32 s49, s93, 7
    s_add_u32 s48, s48, s49
    v_add_u32 v12, s48, v12
    v_add_u32 v13, s48, v13
    v_add_u32 v14, s48, v14
    v_add_u32 v15, s48, v15
    s_lshl_b32 s89, s45, 12
    s_lshr_b32 s50, s44, 2
    s_add_u32 s90, s91, s50
    s_lshl_b32 s50, s50, 14
    s_add_u32 s89, s89, s50
    s_mul_i32 s54, s53, 74
    s_lshr_b32 s54, s54, 9
    s_mul_i32 s55, s54, 7
    s_sub_u32 s55, s53, s55
    s_and_b32 s56, s52, 4
    s_add_u32 s54, s54, s56
    s_and_b32 s48, s52, 3
    s_mul_i32 s48, s48, 7
    s_add_u32 s55, s55, s48
    s_lshr_b32 s50, s44, 2
    s_lshl_b32 s48, s50, 1
    s_add_u32 s48, s48, s45
    s_and_b32 s48, s48, 3
    s_lshl_b32 s57, s54, 2
    s_add_u32 s57, s57, s48
    s_lshl_b32 s51, s54, 12
    s_add_u32 s51, s51, 14811136
    s_lshl_b32 s57, s57, 1
    s_add_u32 s57, s57, s50
    s_lshl_b32 s58, s57, 15
    s_add_u32 s58, s58, 2097152
    v_lshlrev_b32 v16, 2, v1
    v_bfe_u32 v3, v1, 3, 1
    v_lshlrev_b32 v3, 1, v3
    v_bfe_u32 v4, v1, 4, 1
    v_xor_b32 v3, v3, v4
    v_lshlrev_b32 v24, 5, v3
    v_lshl_add_u32 v24, v4, 13, v24
    v_and_b32 v3, 1, v1
    v_lshl_add_u32 v24, v3, 4, v24
    v_bfe_u32 v3, v1, 1, 1
    v_lshl_add_u32 v24, v3, 3, v24
    v_bfe_u32 v3, v1, 2, 2
    v_lshl_add_u32 v24, v3, 7, v24
    v_lshrrev_b32 v3, 5, v1
    v_lshl_add_u32 v24, v3, 10, v24
    v_xor_b32 v25, 32, v24
    v_xor_b32 v26, 64, v24
    v_xor_b32 v27, 96, v24
    v_add_u32 v20, 65536, v24
    v_add_u32 v21, 65536, v25
    v_add_u32 v22, 65536, v26
    v_add_u32 v23, 65536, v27
    v_cmp_gt_u32 s[60:61], 32, v1
    s_lshl_b32 s50, s57, 12
    s_add_u32 s50, s50, 12582912
    s_mul_i32 s62, s57, 114688
    s_lshl_b32 s49, s55, 12
    s_add_u32 s62, s62, s49
    s_add_u32 s62, s62, 4194304
    s_lshl_b32 s63, s54, 5
    s_add_u32 s63, s63, s55
    s_lshl_b32 s63, s63, 7
    s_add_u32 s63, s63, 15073280
    s_cmp_ge_u32 s44, 4
    s_cbranch_scc1 P3_NOSIG
    v_mov_b32 v4, 1
    s_mov_b64 exec, 1
    s_waitcnt vmcnt(0)
    ds_add_rtn_u32 v5, v11, v4 offset:4
    s_waitcnt lgkmcnt(0)
    v_readfirstlane_b32 s48, v5
    s_mov_b64 exec, -1
    s_cmp_lg_u32 s48, 3
    s_cbranch_scc1 SIG_18
    v_mov_b32 v3, s46
    v_lshlrev_b32 v4, 28, v1
    buffer_store_dword v3, v4, s[40:43], s94 offen sc1
SIG_18:
P3_NOSIG:
    ds_read_b32 v6, v11 offset:32
    s_cmp_ge_u32 s53, 28
    s_cbranch_scc1 P4_PRE
    v_add_u32 v3, 148480, v2
    s_cmp_lg_u32 s44, 0
    s_cbranch_scc1 P3_NOP
    v_min_u32 v10, 31, v1
    v_lshlrev_b32 v10, 7, v10
    s_mov_b32 s49, 0x40000
    buffer_load_dword v8, v10, s[40:43], s51 offen sc1
    s_sleep 4
POLL_19:
    buffer_load_dword v9, v10, s[40:43], s51 offen sc1
    s_waitcnt vmcnt(1)
    v_cmp_ne_u32 vcc, s46, v8
    s_nop 4
    s_cbranch_vccz POLLD_20
    buffer_load_dword v8, v10, s[40:43], s51 offen sc1
    s_waitcnt vmcnt(1)
    v_cmp_ne_u32 vcc, s46, v9
    s_nop 4
    s_cbranch_vccz POLLD_20
    s_sub_u32 s49, s49, 1
    s_cbranch_scc0 POLL_19
POLLD_20:
P3_NOP:
    s_waitcnt lgkmcnt(0)
    v_readfirstlane_b32 s46, v6
    s_barrier
    s_xor_b32 s59, s56, 0
    s_lshl_b32 s59, s59, 12
    s_add_u32 s59, s59, s58
    buffer_load_dwordx4 v[152:155], v2, s[40:43], s59 offen offset:0 sc1
    buffer_load_dwordx4 v[156:159], v2, s[40:43], s59 offen offset:1024 sc1
    buffer_load_dwordx4 v[160:163], v2, s[40:43], s59 offen offset:2048 sc1
    buffer_load_dwordx4 v[164:167], v2, s[40:43], s59 offen offset:3072 sc1
    s_xor_b32 s59, s56, 1
    s_lshl_b32 s59, s59, 12
    s_add_u32 s59, s59, s58
    buffer_load_dwordx4 v[168:171], v2, s[40:43], s59 offen offset:0 sc1
    buffer_load_dwordx4 v[172:175], v2, s[40:43], s59 offen offset:1024 sc1
    ds_read_b128 v[132:135], v3 offset:0
    ds_read_b128 v[136:139], v3 offset:1024
    ds_read_b128 v[140:143], v3 offset:2048
    ds_read_b128 v[144:147], v3 offset:3072
    ds_read_b64_tr_b16 v[92:93], v20 offset:0
    ds_read_b64_tr_b16 v[94:95], v20 offset:512
    ds_read_b64_tr_b16 v[96:97], v21 offset:0
    ds_read_b64_tr_b16 v[98:99], v21 offset:512
    ds_read_b64_tr_b16 v[100:101], v22 offset:0
    ds_read_b64_tr_b16 v[102:103], v22 offset:512
    ds_read_b64_tr_b16 v[104:105], v23 offset:0
    ds_read_b64_tr_b16 v[106:107], v23 offset:512
    s_waitcnt vmcnt(5) lgkmcnt(4)
    v_mfma_f32_32x32x16_bf16 v[28:43], v[92:95], v[152:155], 0
    s_setprio 1
    v_mfma_f32_32x32x16_bf16 v[44:59], v[96:99], v[152:155], 0
    s_setprio 0
    ds_read_b64_tr_b16 v[108:109], v20 offset:2048
    ds_read_b64_tr_b16 v[110:111], v20 offset:2560
    ds_read_b64_tr_b16 v[112:113], v21 offset:2048
    ds_read_b64_tr_b16 v[114:115], v21 offset:2560
    buffer_load_dwordx4 v[176:179], v2, s[40:43], s59 offen offset:2048 sc1
    s_waitcnt lgkmcnt(4)
    v_mfma_f32_32x32x16_bf16 v[60:75], v[100:103], v[152:155], 0
    s_setprio 1
    v_mfma_f32_32x32x16_bf16 v[76:91], v[104:107], v[152:155], 0
    s_setprio 0
    ds_read_b64_tr_b16 v[92:93], v22 offset:2048
    ds_read_b64_tr_b16 v[94:95], v22 offset:2560
    ds_read_b64_tr_b16 v[96:97], v23 offset:2048
    ds_read_b64_tr_b16 v[98:99], v23 offset:2560
    buffer_load_dwordx4 v[180:183], v2, s[40:43], s59 offen offset:3072 sc1
    s_waitcnt vmcnt(6) lgkmcnt(4)
    v_mfma_f32_32x32x16_bf16 v[28:43], v[108:111], v[156:159], v[28:43]
    s_setprio 1
    v_mfma_f32_32x32x16_bf16 v[44:59], v[112:115], v[156:159], v[44:59]
    s_setprio 0
    ds_read_b64_tr_b16 v[100:101], v20 offset:4096
    ds_read_b64_tr_b16 v[102:103], v20 offset:4608
    ds_read_b64_tr_b16 v[104:105], v21 offset:4096
    ds_read_b64_tr_b16 v[106:107], v21 offset:4608
    s_xor_b32 s59, s56, 2
    s_lshl_b32 s59, s59, 12
    s_add_u32 s59, s59, s58
    buffer_load_dwordx4 v[184:187], v2, s[40:43], s59 offen offset:0 sc1
    s_waitcnt lgkmcnt(4)
    v_mfma_f32_32x32x16_bf16 v[60:75], v[92:95], v[156:159], v[60:75]
    s_setprio 1
    v_mfma_f32_32x32x16_bf16 v[76:91], v[96:99], v[156:159], v[76:91]
    s_setprio 0
    ds_read_b64_tr_b16 v[108:109], v22 offset:4096
    ds_read_b64_tr_b16 v[110:111], v22 offset:4608
    ds_read_b64_tr_b16 v[112:113], v23 offset:4096
    ds_read_b64_tr_b16 v[114:115], v23 offset:4608
    s_waitcnt vmcnt(6) lgkmcnt(4)
    v_mfma_f32_32x32x16_bf16 v[28:43], v[100:103], v[160:163], v[28:43]
    s_setprio 1
    v_mfma_f32_32x32x16_bf16 v[44:59], v[104:107], v[160:163], v[44:59]
    s_setprio 0
    ds_read_b64_tr_b16 v[92:93], v20 offset:6144
    ds_read_b64_tr_b16 v[94:95], v20 offset:6656
    ds_read_b64_tr_b16 v[96:97], v21 offset:6144
    ds_read_b64_tr_b16 v[98:99], v21 offset:6656
    buffer_load_dwordx4 v[188:191], v2, s[40:43], s59 offen offset:1024 sc1
    s_waitcnt lgkmcnt(4)
    v_mfma_f32_32x32x16_bf16 v[60:75], v[108:111], v[160:163], v[60:75]
    s_setprio 1
    v_mfma_f32_32x32x16_bf16 v[76:91], v[112:115], v[160:163], v[76:91]
    s_setprio 0
    ds_read_b64_tr_b16 v[100:101], v22 offset:6144
    ds_read_b64_tr_b16 v[102:103], v22 offset:6656
    ds_read_b64_tr_b16 v[104:105], v23 offset:6144
    ds_read_b64_tr_b16 v[106:107], v23 offset:6656
    s_waitcnt vmcnt(6) lgkmcnt(4)
    v_mfma_f32_32x32x16_bf16 v[28:43], v[92:95], v[164:167], v[28:43]
    s_setprio 1
    v_mfma_f32_32x32x16_bf16 v[44:59], v[96:99], v[164:167], v[44:59]
    s_setprio 0
    ds_read_b64_tr_b16 v[108:109], v20 offset:16384
    ds_read_b64_tr_b16 v[110:111], v20 offset:16896
    ds_read_b64_tr_b16 v[112:113], v21 offset:16384
    ds_read_b64_tr_b16 v[114:115], v21 offset:16896
    buffer_load_dwordx4 v[192:195], v2, s[40:43], s59 offen offset:2048 sc1
    s_waitcnt lgkmcnt(4)
    v_mfma_f32_32x32x16_bf16 v[60:75], v[100:103], v[164:167], v[60:75]
    s_setprio 1
    v_mfma_f32_32x32x16_bf16 v[76:91], v[104:107], v[164:167], v[76:91]
    s_setprio 0
    ds_read_b64_tr_b16 v[92:93], v22 offset:16384
    ds_read_b64_tr_b16 v[94:95], v22 offset:16896
    ds_read_b64_tr_b16 v[96:97], v23 offset:16384
    ds_read_b64_tr_b16 v[98:99], v23 offset:16896
    s_waitcnt vmcnt(6) lgkmcnt(4)
    v_mfma_f32_32x32x16_bf16 v[28:43], v[108:111], v[168:171], v[28:43]
    s_setprio 1
    v_mfma_f32_32x32x16_bf16 v[44:59], v[112:115], v[168:171], v[44:59]
    s_setprio 0
    ds_read_b64_tr_b16 v[100:101], v20 offset:18432
    ds_read_b64_tr_b16 v[102:103], v20 offset:18944
    ds_read_b64_tr_b16 v[104:105], v21 offset:18432
    ds_read_b64_tr_b16 v[106:107], v21 offset:18944
    buffer_load_dwordx4 v[196:199], v2, s[40:43], s59 offen offset:3072 sc1
    s_waitcnt lgkmcnt(4)
    v_mfma_f32_32x32x16_bf16 v[60:75], v[92:95], v[168:171], v[60:75]
    s_setprio 1
    v_mfma_f32_32x32x16_bf16 v[76:91], v[96:99], v[168:171], v[76:91]
    s_setprio 0
    ds_read_b64_tr_b16 v[108:109], v22 offset:18432
    ds_read_b64_tr_b16 v[110:111], v22 offset:18944
    ds_read_b64_tr_b16 v[112:113], v23 offset:18432
    ds_read_b64_tr_b16 v[114:115], v23 offset:18944
    s_waitcnt vmcnt(6) lgkmcnt(4)
    v_mfma_f32_32x32x16_bf16 v[28:43], v[100:103], v[172:175], v[28:43]
    s_setprio 1
    v_mfma_f32_32x32x16_bf16 v[44:59], v[104:107], v[172:175], v[44:59]
    s_setprio 0
    ds_read_b64_tr_b16 v[92:93], v20 offset:20480
    ds_read_b64_tr_b16 v[94:95], v20 offset:20992
    ds_read_b64_tr_b16 v[96:97], v21 offset:20480
    ds_read_b64_tr_b16 v[98:99], v21 offset:20992
    s_xor_b32 s59, s56, 3
    s_lshl_b32 s59, s59, 12
    s_add_u32 s59, s59, s58
    buffer_load_dwordx4 v[200:203], v2, s[40:43], s59 offen offset:0 sc1
    s_waitcnt lgkmcnt(4)
    v_mfma_f32_32x32x16_bf16 v[60:75], v[108:111], v[172:175], v[60:75]
    s_setprio 1
    v_mfma_f32_32x32x16_bf16 v[76:91], v[112:115], v[172:175], v[76:91]
    s_setprio 0
    ds_read_b64_tr_b16 v[100:101], v22 offset:20480
    ds_read_b64_tr_b16 v[102:103], v22 offset:20992
    ds_read_b64_tr_b16 v[104:105], v23 offset:20480
    ds_read_b64_tr_b16 v[106:107], v23 offset:20992
    s_waitcnt vmcnt(6) lgkmcnt(4)
    v_mfma_f32_32x32x16_bf16 v[28:43], v[92:95], v[176:179], v[28:43]
    s_setprio 1
    v_mfma_f32_32x32x16_bf16 v[44:59], v[96:99], v[176:179], v[44:59]
    s_setprio 0
    ds_read_b64_tr_b16 v[108:109], v20 offset:22528
    ds_read_b64_tr_b16 v[110:111], v20 offset:23040
    ds_read_b64_tr_b16 v[112:113], v21 offset:22528
    ds_read_b64_tr_b16 v[114:115], v21 offset:23040
    buffer_load_dwordx4 v[204:207], v2, s[40:43], s59 offen offset:1024 sc1
    s_waitcnt lgkmcnt(4)
    v_mfma_f32_32x32x16_bf16 v[60:75], v[100:103], v[176:179], v[60:75]
    s_setprio 1
    v_mfma_f32_32x32x16_bf16 v[76:91], v[104:107], v[176:179], v[76:91]
    s_setprio 0
    ds_read_b64_tr_b16 v[92:93], v22 offset:22528
    ds_read_b64_tr_b16 v[94:95], v22 offset:23040
    ds_read_b64_tr_b16 v[96:97], v23 offset:22528
    ds_read_b64_tr_b16 v[98:99], v23 offset:23040
    s_waitcnt vmcnt(6) lgkmcnt(4)
    v_mfma_f32_32x32x16_bf16 v[28:43], v[108:111], v[180:183], v[28:43]
    s_setprio 1
    v_mfma_f32_32x32x16_bf16 v[44:59], v[112:115], v[180:183], v[44:59]
    s_setprio 0
    ds_read_b64_tr_b16 v[100:101], v20 offset:32768
    ds_read_b64_tr_b16 v[102:103], v20 offset:33280
    ds_read_b64_tr_b16 v[104:105], v21 offset:32768
    ds_read_b64_tr_b16 v[106:107], v21 offset:33280
    buffer_load_dwordx4 v[208:211], v2, s[40:43], s59 offen offset:2048 sc1
    s_waitcnt lgkmcnt(4)
    v_mfma_f32_32x32x16_bf16 v[60:75], v[92:95], v[180:183], v[60:75]
    s_setprio 1
    v_mfma_f32_32x32x16_bf16 v[76:91], v[96:99], v[180:183], v[76:91]
    s_setprio 0
    ds_read_b64_tr_b16 v[108:109], v22 offset:32768
    ds_read_b64_tr_b16 v[110:111], v22 offset:33280
    ds_read_b64_tr_b16 v[112:113], v23 offset:32768
    ds_read_b64_tr_b16 v[114:115], v23 offset:33280
    s_waitcnt vmcnt(6) lgkmcnt(4)
    v_mfma_f32_32x32x16_bf16 v[28:43], v[100:103], v[184:187], v[28:43]
    s_setprio 1
    v_mfma_f32_32x32x16_bf16 v[44:59], v[104:107], v[184:187], v[44:59]
    s_setprio 0
    ds_read_b64_tr_b16 v[92:93], v20 offset:34816
    ds_read_b64_tr_b16 v[94:95], v20 offset:35328
    ds_read_b64_tr_b16 v[96:97], v21 offset:34816
    ds_read_b64_tr_b16 v[98:99], v21 offset:35328
    buffer_load_dwordx4 v[212:215], v2, s[40:43], s59 offen offset:3072 sc1
    s_waitcnt lgkmcnt(4)
    v_mfma_f32_32x32x16_bf16 v[60:75], v[108:111], v[184:187], v[60:75]
    s_setprio 1
    v_mfma_f32_32x32x16_bf16 v[76:91], v[112:115], v[184:187], v[76:91]
    s_setprio 0
    ds_read_b64_tr_b16 v[100:101], v22 offset:34816
    ds_read_b64_tr_b16 v[102:103], v22 offset:35328
    ds_read_b64_tr_b16 v[104:105], v23 offset:34816
    ds_read_b64_tr_b16 v[106:107], v23 offset:35328
    s_waitcnt vmcnt(6) lgkmcnt(4)
    v_mfma_f32_32x32x16_bf16 v[28:43], v[92:95], v[188:191], v[28:43]
    s_setprio 1
    v_mfma_f32_32x32x16_bf16 v[44:59], v[96:99], v[188:191], v[44:59]
    s_setprio 0
    ds_read_b64_tr_b16 v[108:109], v20 offset:36864
    ds_read_b64_tr_b16 v[110:111], v20 offset:37376
    ds_read_b64_tr_b16 v[112:113], v21 offset:36864
    ds_read_b64_tr_b16 v[114:115], v21 offset:37376
    buffer_load_dword v116, v16, s[40:43], s50 offen offset:0 sc1
    buffer_load_dword v117, v16, s[40:43], s50 offen offset:256 sc1
    buffer_load_dword v118, v16, s[40:43], s50 offen offset:512 sc1
    buffer_load_dword v119, v16, s[40:43], s50 offen offset:768 sc1
    s_waitcnt lgkmcnt(4)
    v_mfma_f32_32x32x16_bf16 v[60:75], v[100:103], v[188:191], v[60:75]
    s_setprio 1
    v_mfma_f32_32x32x16_bf16 v[76:91], v[104:107], v[188:191], v[76:91]
    s_setprio 0
    ds_read_b64_tr_b16 v[92:93], v22 offset:36864
    ds_read_b64_tr_b16 v[94:95], v22 offset:37376
    ds_read_b64_tr_b16 v[96:97], v23 offset:36864
    ds_read_b64_tr_b16 v[98:99], v23 offset:37376
    buffer_load_dword v120, v16, s[40:43], s50 offen offset:1024 sc1
    buffer_load_dword v121, v16, s[40:43], s50 offen offset:1280 sc1
    buffer_load_dword v122, v16, s[40:43], s50 offen offset:1536 sc1
    buffer_load_dword v123, v16, s[40:43], s50 offen offset:1792 sc1
    s_waitcnt vmcnt(13) lgkmcnt(4)
    v_mfma_f32_32x32x16_bf16 v[28:43], v[108:111], v[192:195], v[28:43]
    s_setprio 1
    v_mfma_f32_32x32x16_bf16 v[44:59], v[112:115], v[192:195], v[44:59]
    s_setprio 0
    ds_read_b64_tr_b16 v[100:101], v20 offset:38912
    ds_read_b64_tr_b16 v[102:103], v20 offset:39424
    ds_read_b64_tr_b16 v[104:105], v21 offset:38912
    ds_read_b64_tr_b16 v[106:107], v21 offset:39424
    buffer_load_dword v124, v16, s[40:43], s50 offen offset:2048 sc1
    buffer_load_dword v125, v16, s[40:43], s50 offen offset:2304 sc1
    buffer_load_dword v126, v16, s[40:43], s50 offen offset:2560 sc1
    buffer_load_dword v127, v16, s[40:43], s50 offen offset:2816 sc1
    s_waitcnt lgkmcnt(4)
    v_mfma_f32_32x32x16_bf16 v[60:75], v[92:95], v[192:195], v[60:75]
    s_setprio 1
    v_mfma_f32_32x32x16_bf16 v[76:91], v[96:99], v[192:195], v[76:91]
    s_setprio 0
    ds_read_b64_tr_b16 v[108:109], v22 offset:38912
    ds_read_b64_tr_b16 v[110:111], v22 offset:39424
    ds_read_b64_tr_b16 v[112:113], v23 offset:38912
    ds_read_b64_tr_b16 v[114:115], v23 offset:39424
    buffer_load_dword v128, v16, s[40:43], s50 offen offset:3072 sc1
    buffer_load_dword v129, v16, s[40:43], s50 offen offset:3328 sc1
    buffer_load_dword v130, v16, s[40:43], s50 offen offset:3584 sc1
    buffer_load_dword v131, v16, s[40:43], s50 offen offset:3840 sc1
    s_waitcnt vmcnt(20) lgkmcnt(4)
    v_mfma_f32_32x32x16_bf16 v[28:43], v[100:103], v[196:199], v[28:43]
    s_setprio 1
    v_mfma_f32_32x32x16_bf16 v[44:59], v[104:107], v[196:199], v[44:59]
    s_setprio 0
    ds_read_b64_tr_b16 v[92:93], v20 offset:49152
    ds_read_b64_tr_b16 v[94:95], v20 offset:49664
    ds_read_b64_tr_b16 v[96:97], v21 offset:49152
    ds_read_b64_tr_b16 v[98:99], v21 offset:49664
    s_xor_b32 s59, s56, 4
    s_lshl_b32 s59, s59, 12
    s_add_u32 s59, s59, s58
    buffer_load_dwordx4 v[216:219], v2, s[40:43], s59 offen offset:0 sc1
    s_waitcnt lgkmcnt(4)
    v_mfma_f32_32x32x16_bf16 v[60:75], v[108:111], v[196:199], v[60:75]
    s_setprio 1
    v_mfma_f32_32x32x16_bf16 v[76:91], v[112:115], v[196:199], v[76:91]
    s_setprio 0
    ds_read_b64_tr_b16 v[100:101], v22 offset:49152
    ds_read_b64_tr_b16 v[102:103], v22 offset:49664
    ds_read_b64_tr_b16 v[104:105], v23 offset:49152
    ds_read_b64_tr_b16 v[106:107], v23 offset:49664
    buffer_load_dwordx4 v[220:223], v2, s[40:43], s59 offen offset:1024 sc1
    s_waitcnt vmcnt(21) lgkmcnt(4)
    v_mfma_f32_32x32x16_bf16 v[28:43], v[92:95], v[200:203], v[28:43]
    s_setprio 1
    v_mfma_f32_32x32x16_bf16 v[44:59], v[96:99], v[200:203], v[44:59]
    s_setprio 0
    ds_read_b64_tr_b16 v[108:109], v20 offset:51200
    ds_read_b64_tr_b16 v[110:111], v20 offset:51712
    ds_read_b64_tr_b16 v[112:113], v21 offset:51200
    ds_read_b64_tr_b16 v[114:115], v21 offset:51712
    buffer_load_dwordx4 v[224:227], v2, s[40:43], s59 offen offset:2048 sc1
    s_waitcnt lgkmcnt(4)
    v_mfma_f32_32x32x16_bf16 v[60:75], v[100:103], v[200:203], v[60:75]
    s_setprio 1
    v_mfma_f32_32x32x16_bf16 v[76:91], v[104:107], v[200:203], v[76:91]
    s_setprio 0
    ds_read_b64_tr_b16 v[92:93], v22 offset:51200
    ds_read_b64_tr_b16 v[94:95], v22 offset:51712
    ds_read_b64_tr_b16 v[96:97], v23 offset:51200
    ds_read_b64_tr_b16 v[98:99], v23 offset:51712
    buffer_load_dwordx4 v[228:231], v2, s[40:43], s59 offen offset:3072 sc1
    s_waitcnt vmcnt(22) lgkmcnt(4)
    v_mfma_f32_32x32x16_bf16 v[28:43], v[108:111], v[204:207], v[28:43]
    s_setprio 1
    v_mfma_f32_32x32x16_bf16 v[44:59], v[112:115], v[204:207], v[44:59]
    s_setprio 0
    ds_read_b64_tr_b16 v[100:101], v20 offset:53248
    ds_read_b64_tr_b16 v[102:103], v20 offset:53760
    ds_read_b64_tr_b16 v[104:105], v21 offset:53248
    ds_read_b64_tr_b16 v[106:107], v21 offset:53760
    s_xor_b32 s59, s56, 5
    s_lshl_b32 s59, s59, 12
    s_add_u32 s59, s59, s58
    buffer_load_dwordx4 v[232:235], v2, s[40:43], s59 offen offset:0 sc1
    s_waitcnt lgkmcnt(4)
    v_mfma_f32_32x32x16_bf16 v[60:75], v[92:95], v[204:207], v[60:75]
    s_setprio 1
    v_mfma_f32_32x32x16_bf16 v[76:91], v[96:99], v[204:207], v[76:91]
    s_setprio 0
    ds_read_b64_tr_b16 v[108:109], v22 offset:53248
    ds_read_b64_tr_b16 v[110:111], v22 offset:53760
    ds_read_b64_tr_b16 v[112:113], v23 offset:53248
    ds_read_b64_tr_b16 v[114:115], v23 offset:53760
    buffer_load_dwordx4 v[236:239], v2, s[40:43], s59 offen offset:1024 sc1
    s_waitcnt vmcnt(23) lgkmcnt(4)
    v_mfma_f32_32x32x16_bf16 v[28:43], v[100:103], v[208:211], v[28:43]
    s_setprio 1
    v_mfma_f32_32x32x16_bf16 v[44:59], v[104:107], v[208:211], v[44:59]
    s_setprio 0
    ds_read_b64_tr_b16 v[92:93], v20 offset:55296
    ds_read_b64_tr_b16 v[94:95], v20 offset:55808
    ds_read_b64_tr_b16 v[96:97], v21 offset:55296
    ds_read_b64_tr_b16 v[98:99], v21 offset:55808
    buffer_load_dwordx4 v[240:243], v2, s[40:43], s59 offen offset:2048 sc1
    s_waitcnt lgkmcnt(4)
    v_mfma_f32_32x32x16_bf16 v[60:75], v[108:111], v[208:211], v[60:75]
    s_setprio 1
    v_mfma_f32_32x32x16_bf16 v[76:91], v[112:115], v[208:211], v[76:91]
    s_setprio 0
    ds_read_b64_tr_b16 v[100:101], v22 offset:55296
    ds_read_b64_tr_b16 v[102:103], v22 offset:55808
    ds_read_b64_tr_b16 v[104:105], v23 offset:55296
    ds_read_b64_tr_b16 v[106:107], v23 offset:55808
    buffer_load_dwordx4 v[244:247], v2, s[40:43], s59 offen offset:3072 sc1
    s_waitcnt vmcnt(8) lgkmcnt(4)
    v_mfma_f32_32x32x16_bf16 v[28:43], v[92:95], v[212:215], v[28:43]
    s_setprio 1
    v_mfma_f32_32x32x16_bf16 v[44:59], v[96:99], v[212:215], v[44:59]
    s_setprio 0
    ds_read_b64_tr_b16 v[108:109], v24 offset:0
    ds_read_b64_tr_b16 v[110:111], v24 offset:512
    ds_read_b64_tr_b16 v[112:113], v25 offset:0
    ds_read_b64_tr_b16 v[114:115], v25 offset:512
    s_xor_b32 s59, s56, 6
    s_lshl_b32 s59, s59, 12
    s_add_u32 s59, s59, s58
    buffer_load_dwordx4 v[248:251], v2, s[40:43], s59 offen offset:0 sc1
    v_add_f32 v132, v132, v136
    v_add_f32 v133, v133, v137
    v_add_f32 v134, v134, v138
    v_add_f32 v135, v135, v139
    v_add_f32 v140, v140, v144
    v_add_f32 v141, v141, v145
    s_waitcnt lgkmcnt(4)
    v_mfma_f32_32x32x16_bf16 v[60:75], v[100:103], v[212:215], v[60:75]
    s_setprio 1
    v_mfma_f32_32x32x16_bf16 v[76:91], v[104:107], v[212:215], v[76:91]
    s_setprio 0
    ds_read_b64_tr_b16 v[92:93], v26 offset:0
    ds_read_b64_tr_b16 v[94:95], v26 offset:512
    ds_read_b64_tr_b16 v[96:97], v27 offset:0
    ds_read_b64_tr_b16 v[98:99], v27 offset:512
    buffer_load_dwordx4 v[252:255], v2, s[40:43], s59 offen offset:1024 sc1
    v_add_f32 v142, v142, v146
    v_add_f32 v143, v143, v147
    v_add_f32 v116, v116, v124
    v_add_f32 v117, v117, v125
    v_add_f32 v118, v118, v126
    v_add_f32 v119, v119, v127
    s_barrier
    s_waitcnt vmcnt(9) lgkmcnt(4)
    v_mfma_f32_32x32x16_bf16 v[28:43], v[108:111], v[216:219], v[28:43]
    s_setprio 1
    v_mfma_f32_32x32x16_bf16 v[44:59], v[112:115], v[216:219], v[44:59]
    s_setprio 0
    ds_read_b64_tr_b16 v[100:101], v24 offset:2048
    ds_read_b64_tr_b16 v[102:103], v24 offset:2560
    ds_read_b64_tr_b16 v[104:105], v25 offset:2048
    ds_read_b64_tr_b16 v[106:107], v25 offset:2560
    buffer_load_dwordx4 v[152:155], v2, s[40:43], s59 offen offset:2048 sc1
    v_add_f32 v120, v120, v128
    v_add_f32 v121, v121, v129
    v_add_f32 v122, v122, v130
    v_add_f32 v123, v123, v131
    v_add_f32 v116, v116, v120
    v_add_f32 v117, v117, v121
    s_waitcnt lgkmcnt(4)
    v_mfma_f32_32x32x16_bf16 v[60:75], v[92:95], v[216:219], v[60:75]
    s_setprio 1
    v_mfma_f32_32x32x16_bf16 v[76:91], v[96:99], v[216:219], v[76:91]
    s_setprio 0
    ds_read_b64_tr_b16 v[108:109], v26 offset:2048
    ds_read_b64_tr_b16 v[110:111], v26 offset:2560
    ds_read_b64_tr_b16 v[112:113], v27 offset:2048
    ds_read_b64_tr_b16 v[114:115], v27 offset:2560
    buffer_load_dwordx4 v[156:159], v2, s[40:43], s59 offen offset:3072 sc1
    v_add_f32 v118, v118, v122
    v_add_f32 v119, v119, v123
    v_add_f32 v124, v132, v140
    v_add_f32 v125, v133, v141
    v_add_f32 v126, v134, v142
    v_add_f32 v127, v135, v143
    s_waitcnt vmcnt(10) lgkmcnt(4)
    v_mfma_f32_32x32x16_bf16 v[28:43], v[100:103], v[220:223], v[28:43]
    s_setprio 1
    v_mfma_f32_32x32x16_bf16 v[44:59], v[104:107], v[220:223], v[44:59]
    s_setprio 0
    ds_read_b64_tr_b16 v[92:93], v24 offset:4096
    ds_read_b64_tr_b16 v[94:95], v24 offset:4608
    ds_read_b64_tr_b16 v[96:97], v25 offset:4096
    ds_read_b64_tr_b16 v[98:99], v25 offset:4608
    s_xor_b32 s59, s56, 7
    s_lshl_b32 s59, s59, 12
    s_add_u32 s59, s59, s58
    buffer_load_dwordx4 v[160:163], v2, s[40:43], s59 offen offset:0 sc1
    v_add_f32 v116, v116, v118
    v_add_f32 v117, v117, v119
    v_add_f32 v116, v116, v117
    v_mov_b32 v17, v116
    v_cvt_pk_bf16_f32 v132, v124, v124
    v_cvt_pk_bf16_f32 v136, v125, v125
    s_waitcnt lgkmcnt(4)
    v_mfma_f32_32x32x16_bf16 v[60:75], v[108:111], v[220:223], v[60:75]
    s_setprio 1
    v_mfma_f32_32x32x16_bf16 v[76:91], v[112:115], v[220:223], v[76:91]
    s_setprio 0
    ds_read_b64_tr_b16 v[100:101], v26 offset:4096
    ds_read_b64_tr_b16 v[102:103], v26 offset:4608
    ds_read_b64_tr_b16 v[104:105], v27 offset:4096
    ds_read_b64_tr_b16 v[106:107], v27 offset:4608
    buffer_load_dwordx4 v[164:167], v2, s[40:43], s59 offen offset:1024 sc1
    v_cvt_pk_bf16_f32 v140, v126, v126
    v_cvt_pk_bf16_f32 v144, v127, v127
    v_permlane32_swap_b32 v17, v116
    v_and_b32 v135, 0xffff0000, v132
    v_and_b32 v139, 0xffff0000, v136
    v_and_b32 v143, 0xffff0000, v140
    s_waitcnt vmcnt(11) lgkmcnt(4)
    v_mfma_f32_32x32x16_bf16 v[28:43], v[92:95], v[224:227], v[28:43]
    s_setprio 1
    v_mfma_f32_32x32x16_bf16 v[44:59], v[96:99], v[224:227], v[44:59]
    s_setprio 0
    ds_read_b64_tr_b16 v[108:109], v24 offset:6144
    ds_read_b64_tr_b16 v[110:111], v24 offset:6656
    ds_read_b64_tr_b16 v[112:113], v25 offset:6144
    ds_read_b64_tr_b16 v[114:115], v25 offset:6656
    buffer_load_dwordx4 v[168:171], v2, s[40:43], s59 offen offset:2048 sc1
    v_and_b32 v147, 0xffff0000, v144
    v_mul_f32 v17, 0xbb000000, v17
    v_mul_f32 v116, 0x3b000000, v116
    v_sub_f32 v134, v124, v135
    v_sub_f32 v138, v125, v139
    v_sub_f32 v142, v126, v143
    s_waitcnt lgkmcnt(4)
    v_mfma_f32_32x32x16_bf16 v[60:75], v[100:103], v[224:227], v[60:75]
    s_setprio 1
    v_mfma_f32_32x32x16_bf16 v[76:91], v[104:107], v[224:227], v[76:91]
    s_setprio 0
    ds_read_b64_tr_b16 v[92:93], v26 offset:6144
    ds_read_b64_tr_b16 v[94:95], v26 offset:6656
    ds_read_b64_tr_b16 v[96:97], v27 offset:6144
    ds_read_b64_tr_b16 v[98:99], v27 offset:6656
    v_sub_f32 v146, v127, v147
    v_fma_f32 v116, -v17, v17, v116
    v_cvt_pk_bf16_f32 v148, v17, v17
    v_cvt_pk_bf16_f32 v133, v134, v134
    v_cvt_pk_bf16_f32 v137, v138, v138
    v_cvt_pk_bf16_f32 v141, v142, v142
    s_waitcnt vmcnt(11) lgkmcnt(4)
    v_mfma_f32_32x32x16_bf16 v[28:43], v[108:111], v[228:231], v[28:43]
    s_setprio 1
    v_mfma_f32_32x32x16_bf16 v[44:59], v[112:115], v[228:231], v[44:59]
    s_setprio 0
    ds_read_b64_tr_b16 v[100:101], v24 offset:16384
    ds_read_b64_tr_b16 v[102:103], v24 offset:16896
    ds_read_b64_tr_b16 v[104:105], v24 offset:18432
    ds_read_b64_tr_b16 v[106:107], v24 offset:18944
    buffer_load_dwordx4 v[172:175], v2, s[40:43], s59 offen offset:3072 sc1
    v_cvt_pk_bf16_f32 v145, v146, v146
    v_max_f32 v116, 0, v116
    v_and_b32 v149, 0xffff0000, v148
    s_cmp_ge_u32 s90, 7
    s_cselect_b32 s88, 7, 0
    s_sub_u32 s90, s90, s88
    s_lshl_b32 s88, s90, 17
    s_add_u32 s88, s88, s95
    s_add_u32 m0, s89, 65536
    s_add_u32 s90, s90, 2
    buffer_load_dwordx4 v12, s[24:27], s88 offen offset:0 lds
    v_mov_b32 v134, 0
    v_mov_b32 v135, 0
    v_mov_b32 v138, 0
    s_waitcnt lgkmcnt(4)
    v_mfma_f32_32x32x16_bf16 v[60:75], v[92:95], v[228:231], v[60:75]
    s_setprio 1
    v_mfma_f32_32x32x16_bf16 v[76:91], v[96:99], v[228:231], v[76:91]
    s_setprio 0
    ds_read_b64_tr_b16 v[108:109], v24 offset:20480
    ds_read_b64_tr_b16 v[110:111], v24 offset:20992
    ds_read_b64_tr_b16 v[112:113], v24 offset:22528
    ds_read_b64_tr_b16 v[114:115], v24 offset:23040
    v_mov_b32 v139, 0
    v_mov_b32 v142, 0
    v_mov_b32 v143, 0
    buffer_load_dwordx4 v13, s[24:27], s88 offen offset:1024 lds
    v_mov_b32 v146, 0
    v_mov_b32 v147, 0
    v_add_f32 v19, 0x3727c5ac, v116
    s_waitcnt vmcnt(12) lgkmcnt(4)
    v_mfma_f32_32x32x16_bf16 v[28:43], v[100:103], v[232:235], v[28:43]
    s_setprio 1
    v_mfma_f32_32x32x16_bf16 v[28:43], v[104:107], v[236:239], v[28:43]
    s_setprio 0
    ds_read_b64_tr_b16 v[92:93], v24 offset:32768
    ds_read_b64_tr_b16 v[94:95], v24 offset:33280
    ds_read_b64_tr_b16 v[96:97], v24 offset:34816
    ds_read_b64_tr_b16 v[98:99], v24 offset:35328
    v_sub_f32 v149, v17, v149
    v_rsq_f32 v18, v19
    v_cvt_pk_bf16_f32 v148, v17, v149
    buffer_load_dwordx4 v14, s[24:27], s88 offen offset:2048 lds
    v_mov_b32 v150, 0
    v_mov_b32 v151, 0
    v_mul_f32 v18, 0xbfb8aa3b, v18
    s_waitcnt vmcnt(11) lgkmcnt(4)
    v_mfma_f32_32x32x16_bf16 v[28:43], v[108:111], v[240:243], v[28:43]
    s_setprio 1
    v_mfma_f32_32x32x16_bf16 v[28:43], v[112:115], v[244:247], v[28:43]
    s_setprio 0
    ds_read_b64_tr_b16 v[100:101], v24 offset:36864
    ds_read_b64_tr_b16 v[102:103], v24 offset:37376
    ds_read_b64_tr_b16 v[104:105], v24 offset:38912
    ds_read_b64_tr_b16 v[106:107], v24 offset:39424
    v_cndmask_b32 v148, 0, v148, s[60:61]
    v_mov_b32 v149, v148
    buffer_load_dwordx4 v15, s[24:27], s88 offen offset:3072 lds
    s_waitcnt vmcnt(10) lgkmcnt(4)
    v_mfma_f32_32x32x16_bf16 v[28:43], v[92:95], v[248:251], v[28:43]
    s_setprio 1
    v_mfma_f32_32x32x16_bf16 v[28:43], v[96:99], v[252:255], v[28:43]
    s_setprio 0
    ds_read_b64_tr_b16 v[108:109], v24 offset:49152
    ds_read_b64_tr_b16 v[110:111], v24 offset:49664
    ds_read_b64_tr_b16 v[112:113], v24 offset:51200
    ds_read_b64_tr_b16 v[114:115], v24 offset:51712
    s_cmp_ge_u32 s90, 7
    s_cselect_b32 s88, 7, 0
    s_sub_u32 s90, s90, s88
    s_lshl_b32 s88, s90, 17
    s_add_u32 s88, s88, s95
    s_add_u32 m0, s89, 98304
    s_add_u32 s90, s90, 2
    buffer_load_dwordx4 v12, s[24:27], s88 offen offset:0 lds
    s_waitcnt vmcnt(9) lgkmcnt(4)
    v_mfma_f32_32x32x16_bf16 v[28:43], v[100:103], v[152:155], v[28:43]
    s_setprio 1
    v_mfma_f32_32x32x16_bf16 v[28:43], v[104:107], v[156:159], v[28:43]
    s_setprio 0
    ds_read_b64_tr_b16 v[92:93], v24 offset:53248
    ds_read_b64_tr_b16 v[94:95], v24 offset:53760
    ds_read_b64_tr_b16 v[96:97], v24 offset:55296
    ds_read_b64_tr_b16 v[98:99], v24 offset:55808
    buffer_load_dwordx4 v13, s[24:27], s88 offen offset:1024 lds
    s_waitcnt vmcnt(8) lgkmcnt(4)
    v_mfma_f32_32x32x16_bf16 v[28:43], v[108:111], v[160:163], v[28:43]
    s_setprio 1
    v_mfma_f32_32x32x16_bf16 v[28:43], v[112:115], v[164:167], v[28:43]
    s_setprio 0
    ds_read_b64_tr_b16 v[100:101], v25 offset:16384
    ds_read_b64_tr_b16 v[102:103], v25 offset:16896
    ds_read_b64_tr_b16 v[104:105], v25 offset:18432
    ds_read_b64_tr_b16 v[106:107], v25 offset:18944
    buffer_load_dwordx4 v14, s[24:27], s88 offen offset:2048 lds
    s_waitcnt vmcnt(7) lgkmcnt(4)
    v_mfma_f32_32x32x16_bf16 v[28:43], v[132:135], v[148:151], v[28:43]
    s_setprio 1
    v_mfma_f32_32x32x16_bf16 v[44:59], v[136:139], v[148:151], v[44:59]
    v_mfma_f32_32x32x16_bf16 v[60:75], v[140:143], v[148:151], v[60:75]
    v_mfma_f32_32x32x16_bf16 v[76:91], v[144:147], v[148:151], v[76:91]
    v_mfma_f32_32x32x16_bf16 v[28:43], v[92:95], v[168:171], v[28:43]
    v_mfma_f32_32x32x16_bf16 v[28:43], v[96:99], v[172:175], v[28:43]
    s_setprio 0
    ds_read_b64_tr_b16 v[108:109], v25 offset:20480
    ds_read_b64_tr_b16 v[110:111], v25 offset:20992
    ds_read_b64_tr_b16 v[112:113], v25 offset:22528
    ds_read_b64_tr_b16 v[114:115], v25 offset:23040
    buffer_load_dwordx4 v15, s[24:27], s88 offen offset:3072 lds
    s_waitcnt lgkmcnt(4)
    v_mfma_f32_32x32x16_bf16 v[44:59], v[100:103], v[232:235], v[44:59]
    s_setprio 1
    v_mfma_f32_32x32x16_bf16 v[44:59], v[104:107], v[236:239], v[44:59]
    s_setprio 0
    ds_read_b64_tr_b16 v[92:93], v25 offset:32768
    ds_read_b64_tr_b16 v[94:95], v25 offset:33280
    ds_read_b64_tr_b16 v[96:97], v25 offset:34816
    ds_read_b64_tr_b16 v[98:99], v25 offset:35328
    v_mul_f32 v124, v28, v18
    v_exp_f32 v124, v124
    v_mul_f32 v125, v29, v18
    v_mul_f32 v28, v28, v36
    v_exp_f32 v125, v125
    s_waitcnt lgkmcnt(4)
    v_mfma_f32_32x32x16_bf16 v[44:59], v[108:111], v[240:243], v[44:59]
    s_setprio 1
    v_mfma_f32_32x32x16_bf16 v[44:59], v[112:115], v[244:247], v[44:59]
    s_setprio 0
    ds_read_b64_tr_b16 v[100:101], v25 offset:36864
    ds_read_b64_tr_b16 v[102:103], v25 offset:37376
    ds_read_b64_tr_b16 v[104:105], v25 offset:38912
    ds_read_b64_tr_b16 v[106:107], v25 offset:39424
    v_mul_f32 v126, v30, v18
    v_fma_f32 v124, v124, v19, v19
    v_mul_f32 v29, v29, v37
    v_exp_f32 v126, v126
    v_mul_f32 v127, v31, v18
    v_rcp_f32 v124, v124
    v_fma_f32 v125, v125, v19, v19
    v_mul_f32 v30, v30, v38
    v_exp_f32 v127, v127
    v_mul_f32 v128, v32, v18
    s_waitcnt lgkmcnt(4)
    v_mfma_f32_32x32x16_bf16 v[44:59], v[92:95], v[248:251], v[44:59]
    s_setprio 1
    v_mfma_f32_32x32x16_bf16 v[44:59], v[96:99], v[252:255], v[44:59]
    s_setprio 0
    ds_read_b64_tr_b16 v[108:109], v25 offset:49152
    ds_read_b64_tr_b16 v[110:111], v25 offset:49664
    ds_read_b64_tr_b16 v[112:113], v25 offset:51200
    ds_read_b64_tr_b16 v[114:115], v25 offset:51712
    v_mul_f32 v28, v28, v124
    v_rcp_f32 v125, v125
    v_fma_f32 v126, v126, v19, v19
    v_mul_f32 v31, v31, v39
    v_exp_f32 v128, v128
    v_mul_f32 v129, v33, v18
    v_mul_f32 v29, v29, v125
    v_rcp_f32 v126, v126
    v_fma_f32 v127, v127, v19, v19
    v_mul_f32 v32, v32, v40
    s_waitcnt lgkmcnt(4)
    v_mfma_f32_32x32x16_bf16 v[44:59], v[100:103], v[152:155], v[44:59]
    s_setprio 1
    v_mfma_f32_32x32x16_bf16 v[44:59], v[104:107], v[156:159], v[44:59]
    s_setprio 0
    ds_read_b64_tr_b16 v[92:93], v25 offset:53248
    ds_read_b64_tr_b16 v[94:95], v25 offset:53760
    ds_read_b64_tr_b16 v[96:97], v25 offset:55296
    ds_read_b64_tr_b16 v[98:99], v25 offset:55808
    v_exp_f32 v129, v129
    v_mul_f32 v130, v34, v18
    v_mul_f32 v30, v30, v126
    v_rcp_f32 v127, v127
    v_fma_f32 v128, v128, v19, v19
    v_mul_f32 v33, v33, v41
    v_exp_f32 v130, v130
    v_mul_f32 v131, v35, v18
    v_mul_f32 v31, v31, v127
    v_rcp_f32 v128, v128
    s_waitcnt lgkmcnt(4)
    v_mfma_f32_32x32x16_bf16 v[44:59], v[108:111], v[160:163], v[44:59]
    s_setprio 1
    v_mfma_f32_32x32x16_bf16 v[44:59], v[112:115], v[164:167], v[44:59]
    s_setprio 0
    ds_read_b64_tr_b16 v[100:101], v26 offset:16384
    ds_read_b64_tr_b16 v[102:103], v26 offset:16896
    ds_read_b64_tr_b16 v[104:105], v26 offset:18432
    ds_read_b64_tr_b16 v[106:107], v26 offset:18944
    v_fma_f32 v129, v129, v19, v19
    v_mul_f32 v34, v34, v42
    v_exp_f32 v131, v131
    v_mul_f32 v32, v32, v128
    v_rcp_f32 v129, v129
    v_fma_f32 v130, v130, v19, v19
    v_mul_f32 v35, v35, v43
    v_mul_f32 v33, v33, v129
    v_rcp_f32 v130, v130
    v_fma_f32 v131, v131, v19, v19
    s_waitcnt lgkmcnt(4)
    v_mfma_f32_32x32x16_bf16 v[44:59], v[92:95], v[168:171], v[44:59]
    s_setprio 1
    v_mfma_f32_32x32x16_bf16 v[44:59], v[96:99], v[172:175], v[44:59]
    s_setprio 0
    ds_read_b64_tr_b16 v[108:109], v26 offset:20480
    ds_read_b64_tr_b16 v[110:111], v26 offset:20992
    ds_read_b64_tr_b16 v[112:113], v26 offset:22528
    ds_read_b64_tr_b16 v[114:115], v26 offset:23040
    v_mul_f32 v34, v34, v130
    v_rcp_f32 v131, v131
    s_nop 0
    v_mul_f32 v35, v35, v131
    v_cvt_pk_bf16_f32 v36, v28, v29
    v_cvt_pk_bf16_f32 v37, v30, v31
    v_cvt_pk_bf16_f32 v38, v32, v33
    v_cvt_pk_bf16_f32 v39, v34, v35
    buffer_store_dwordx4 v[36:39], v2, s[40:43], s62 offen offset:0 sc1
    s_waitcnt lgkmcnt(4)
    v_mfma_f32_32x32x16_bf16 v[60:75], v[100:103], v[232:235], v[60:75]
    s_setprio 1
    v_mfma_f32_32x32x16_bf16 v[60:75], v[104:107], v[236:239], v[60:75]
    s_setprio 0
    ds_read_b64_tr_b16 v[92:93], v26 offset:32768
    ds_read_b64_tr_b16 v[94:95], v26 offset:33280
    ds_read_b64_tr_b16 v[96:97], v26 offset:34816
    ds_read_b64_tr_b16 v[98:99], v26 offset:35328
    v_mul_f32 v116, v44, v18
    v_exp_f32 v116, v116
    v_mul_f32 v117, v45, v18
    v_mul_f32 v44, v44, v52
    v_exp_f32 v117, v117
    s_waitcnt lgkmcnt(4)
    v_mfma_f32_32x32x16_bf16 v[60:75], v[108:111], v[240:243], v[60:75]
    s_setprio 1
    v_mfma_f32_32x32x16_bf16 v[60:75], v[112:115], v[244:247], v[60:75]
    s_setprio 0
    ds_read_b64_tr_b16 v[100:101], v26 offset:36864
    ds_read_b64_tr_b16 v[102:103], v26 offset:37376
    ds_read_b64_tr_b16 v[104:105], v26 offset:38912
    ds_read_b64_tr_b16 v[106:107], v26 offset:39424
    v_mul_f32 v118, v46, v18
    v_fma_f32 v116, v116, v19, v19
    v_mul_f32 v45, v45, v53
    v_exp_f32 v118, v118
    v_mul_f32 v119, v47, v18
    v_rcp_f32 v116, v116
    v_fma_f32 v117, v117, v19, v19
    v_mul_f32 v46, v46, v54
    v_exp_f32 v119, v119
    v_mul_f32 v120, v48, v18
    s_waitcnt lgkmcnt(4)
    v_mfma_f32_32x32x16_bf16 v[60:75], v[92:95], v[248:251], v[60:75]
    s_setprio 1
    v_mfma_f32_32x32x16_bf16 v[60:75], v[96:99], v[252:255], v[60:75]
    s_setprio 0
    ds_read_b64_tr_b16 v[108:109], v26 offset:49152
    ds_read_b64_tr_b16 v[110:111], v26 offset:49664
    ds_read_b64_tr_b16 v[112:113], v26 offset:51200
    ds_read_b64_tr_b16 v[114:115], v26 offset:51712
    v_mul_f32 v44, v44, v116
    v_rcp_f32 v117, v117
    v_fma_f32 v118, v118, v19, v19
    v_mul_f32 v47, v47, v55
    v_exp_f32 v120, v120
    v_mul_f32 v121, v49, v18
    v_mul_f32 v45, v45, v117
    v_rcp_f32 v118, v118
    v_fma_f32 v119, v119, v19, v19
    v_mul_f32 v48, v48, v56
    s_waitcnt lgkmcnt(4)
    v_mfma_f32_32x32x16_bf16 v[60:75], v[100:103], v[152:155], v[60:75]
    s_setprio 1
    v_mfma_f32_32x32x16_bf16 v[60:75], v[104:107], v[156:159], v[60:75]
    s_setprio 0
    ds_read_b64_tr_b16 v[92:93], v26 offset:53248
    ds_read_b64_tr_b16 v[94:95], v26 offset:53760
    ds_read_b64_tr_b16 v[96:97], v26 offset:55296
    ds_read_b64_tr_b16 v[98:99], v26 offset:55808
    v_exp_f32 v121, v121
    v_mul_f32 v122, v50, v18
    v_mul_f32 v46, v46, v118
    v_rcp_f32 v119, v119
    v_fma_f32 v120, v120, v19, v19
    v_mul_f32 v49, v49, v57
    v_exp_f32 v122, v122
    v_mul_f32 v123, v51, v18
    v_mul_f32 v47, v47, v119
    v_rcp_f32 v120, v120
    s_waitcnt lgkmcnt(4)
    v_mfma_f32_32x32x16_bf16 v[60:75], v[108:111], v[160:163], v[60:75]
    s_setprio 1
    v_mfma_f32_32x32x16_bf16 v[60:75], v[112:115], v[164:167], v[60:75]
    s_setprio 0
    ds_read_b64_tr_b16 v[100:101], v27 offset:16384
    ds_read_b64_tr_b16 v[102:103], v27 offset:16896
    ds_read_b64_tr_b16 v[104:105], v27 offset:18432
    ds_read_b64_tr_b16 v[106:107], v27 offset:18944
    v_fma_f32 v121, v121, v19, v19
    v_mul_f32 v50, v50, v58
    v_exp_f32 v123, v123
    v_mul_f32 v48, v48, v120
    v_rcp_f32 v121, v121
    v_fma_f32 v122, v122, v19, v19
    v_mul_f32 v51, v51, v59
    v_mul_f32 v49, v49, v121
    v_rcp_f32 v122, v122
    v_fma_f32 v123, v123, v19, v19
    s_waitcnt lgkmcnt(4)
    v_mfma_f32_32x32x16_bf16 v[60:75], v[92:95], v[168:171], v[60:75]
    s_setprio 1
    v_mfma_f32_32x32x16_bf16 v[60:75], v[96:99], v[172:175], v[60:75]
    s_setprio 0
    ds_read_b64_tr_b16 v[108:109], v27 offset:20480
    ds_read_b64_tr_b16 v[110:111], v27 offset:20992
    ds_read_b64_tr_b16 v[112:113], v27 offset:22528
    ds_read_b64_tr_b16 v[114:115], v27 offset:23040
    v_mul_f32 v50, v50, v122
    v_rcp_f32 v123, v123
    s_nop 0
    v_mul_f32 v51, v51, v123
    v_cvt_pk_bf16_f32 v52, v44, v45
    v_cvt_pk_bf16_f32 v53, v46, v47
    v_cvt_pk_bf16_f32 v54, v48, v49
    v_cvt_pk_bf16_f32 v55, v50, v51
    buffer_store_dwordx4 v[52:55], v2, s[40:43], s62 offen offset:1024 sc1
    s_waitcnt lgkmcnt(4)
    v_mfma_f32_32x32x16_bf16 v[76:91], v[100:103], v[232:235], v[76:91]
    s_setprio 1
    v_mfma_f32_32x32x16_bf16 v[76:91], v[104:107], v[236:239], v[76:91]
    s_setprio 0
    ds_read_b64_tr_b16 v[92:93], v27 offset:32768
    ds_read_b64_tr_b16 v[94:95], v27 offset:33280
    ds_read_b64_tr_b16 v[96:97], v27 offset:34816
    ds_read_b64_tr_b16 v[98:99], v27 offset:35328
    v_mul_f32 v124, v60, v18
    v_exp_f32 v124, v124
    v_mul_f32 v125, v61, v18
    v_mul_f32 v60, v60, v68
    v_exp_f32 v125, v125
    s_waitcnt lgkmcnt(4)
    v_mfma_f32_32x32x16_bf16 v[76:91], v[108:111], v[240:243], v[76:91]
    s_setprio 1
    v_mfma_f32_32x32x16_bf16 v[76:91], v[112:115], v[244:247], v[76:91]
    s_setprio 0
    ds_read_b64_tr_b16 v[100:101], v27 offset:36864
    ds_read_b64_tr_b16 v[102:103], v27 offset:37376
    ds_read_b64_tr_b16 v[104:105], v27 offset:38912
    ds_read_b64_tr_b16 v[106:107], v27 offset:39424
    v_mul_f32 v126, v62, v18
    v_fma_f32 v124, v124, v19, v19
    v_mul_f32 v61, v61, v69
    v_exp_f32 v126, v126
    v_mul_f32 v127, v63, v18
    v_rcp_f32 v124, v124
    v_fma_f32 v125, v125, v19, v19
    v_mul_f32 v62, v62, v70
    v_exp_f32 v127, v127
    v_mul_f32 v128, v64, v18
    s_waitcnt lgkmcnt(4)
    v_mfma_f32_32x32x16_bf16 v[76:91], v[92:95], v[248:251], v[76:91]
    s_setprio 1
    v_mfma_f32_32x32x16_bf16 v[76:91], v[96:99], v[252:255], v[76:91]
    s_setprio 0
    ds_read_b64_tr_b16 v[108:109], v27 offset:49152
    ds_read_b64_tr_b16 v[110:111], v27 offset:49664
    ds_read_b64_tr_b16 v[112:113], v27 offset:51200
    ds_read_b64_tr_b16 v[114:115], v27 offset:51712
    v_mul_f32 v60, v60, v124
    v_rcp_f32 v125, v125
    v_fma_f32 v126, v126, v19, v19
    v_mul_f32 v63, v63, v71
    v_exp_f32 v128, v128
    v_mul_f32 v129, v65, v18
    v_mul_f32 v61, v61, v125
    v_rcp_f32 v126, v126
    v_fma_f32 v127, v127, v19, v19
    v_mul_f32 v64, v64, v72
    s_waitcnt lgkmcnt(4)
    v_mfma_f32_32x32x16_bf16 v[76:91], v[100:103], v[152:155], v[76:91]
    s_setprio 1
    v_mfma_f32_32x32x16_bf16 v[76:91], v[104:107], v[156:159], v[76:91]
    s_setprio 0
    ds_read_b64_tr_b16 v[92:93], v27 offset:53248
    ds_read_b64_tr_b16 v[94:95], v27 offset:53760
    ds_read_b64_tr_b16 v[96:97], v27 offset:55296
    ds_read_b64_tr_b16 v[98:99], v27 offset:55808
    v_exp_f32 v129, v129
    v_mul_f32 v130, v66, v18
    v_mul_f32 v62, v62, v126
    v_rcp_f32 v127, v127
    v_fma_f32 v128, v128, v19, v19
    v_mul_f32 v65, v65, v73
    v_exp_f32 v130, v130
    v_mul_f32 v131, v67, v18
    v_mul_f32 v63, v63, v127
    v_rcp_f32 v128, v128
    s_waitcnt lgkmcnt(4)
    v_mfma_f32_32x32x16_bf16 v[76:91], v[108:111], v[160:163], v[76:91]
    s_setprio 1
    v_mfma_f32_32x32x16_bf16 v[76:91], v[112:115], v[164:167], v[76:91]
    s_setprio 0
    v_fma_f32 v129, v129, v19, v19
    v_mul_f32 v66, v66, v74
    v_exp_f32 v131, v131
    v_mul_f32 v64, v64, v128
    v_rcp_f32 v129, v129
    v_fma_f32 v130, v130, v19, v19
    v_mul_f32 v67, v67, v75
    v_mul_f32 v65, v65, v129
    v_rcp_f32 v130, v130
    v_fma_f32 v131, v131, v19, v19
    s_waitcnt lgkmcnt(0)
    v_mfma_f32_32x32x16_bf16 v[76:91], v[92:95], v[168:171], v[76:91]
    s_setprio 1
    v_mfma_f32_32x32x16_bf16 v[76:91], v[96:99], v[172:175], v[76:91]
    s_setprio 0
    v_mul_f32 v66, v66, v130
    v_rcp_f32 v131, v131
    s_nop 0
    v_mul_f32 v67, v67, v131
    v_cvt_pk_bf16_f32 v68, v60, v61
    v_cvt_pk_bf16_f32 v69, v62, v63
    v_cvt_pk_bf16_f32 v70, v64, v65
    v_cvt_pk_bf16_f32 v71, v66, v67
    buffer_store_dwordx4 v[68:71], v2, s[40:43], s62 offen offset:2048 sc1
    s_nop 1
    v_pk_mul_f32 v[116:117], v[76:77], v[18:19] op_sel:[0,0] op_sel_hi:[1,0]
    v_pk_mul_f32 v[118:119], v[78:79], v[18:19] op_sel:[0,0] op_sel_hi:[1,0]
    v_pk_mul_f32 v[120:121], v[80:81], v[18:19] op_sel:[0,0] op_sel_hi:[1,0]
    v_pk_mul_f32 v[122:123], v[82:83], v[18:19] op_sel:[0,0] op_sel_hi:[1,0]
    v_exp_f32 v116, v116
    v_exp_f32 v117, v117
    v_exp_f32 v118, v118
    v_exp_f32 v119, v119
    v_exp_f32 v120, v120
    v_exp_f32 v121, v121
    v_exp_f32 v122, v122
    v_exp_f32 v123, v123
    v_pk_mul_f32 v[76:77], v[76:77], v[84:85]
    v_pk_mul_f32 v[78:79], v[78:79], v[86:87]
    v_pk_mul_f32 v[80:81], v[80:81], v[88:89]
    v_pk_mul_f32 v[82:83], v[82:83], v[90:91]
    v_pk_fma_f32 v[116:117], v[116:117], v[18:19], v[18:19] op_sel:[0,1,1] op_sel_hi:[1,1,1]
    v_pk_fma_f32 v[118:119], v[118:119], v[18:19], v[18:19] op_sel:[0,1,1] op_sel_hi:[1,1,1]
    v_pk_fma_f32 v[120:121], v[120:121], v[18:19], v[18:19] op_sel:[0,1,1] op_sel_hi:[1,1,1]
    v_pk_fma_f32 v[122:123], v[122:123], v[18:19], v[18:19] op_sel:[0,1,1] op_sel_hi:[1,1,1]
    v_rcp_f32 v116, v116
    v_rcp_f32 v117, v117
    v_rcp_f32 v118, v118
    v_rcp_f32 v119, v119
    v_rcp_f32 v120, v120
    v_rcp_f32 v121, v121
    v_rcp_f32 v122, v122
    v_rcp_f32 v123, v123
    v_pk_mul_f32 v[76:77], v[76:77], v[116:117]
    v_pk_mul_f32 v[78:79], v[78:79], v[118:119]
    v_pk_mul_f32 v[80:81], v[80:81], v[120:121]
    v_pk_mul_f32 v[82:83], v[82:83], v[122:123]
    v_cvt_pk_bf16_f32 v84, v76, v77
    v_cvt_pk_bf16_f32 v85, v78, v79
    v_cvt_pk_bf16_f32 v86, v80, v81
    v_cvt_pk_bf16_f32 v87, v82, v83
    buffer_store_dwordx4 v[84:87], v2, s[40:43], s62 offen offset:3072 sc1
    s_setprio 0
    s_sub_u32 s63, s63, 131072
    s_branch P4_START
P4_PRE:
    s_barrier
    v_lshlrev_b32 v3, 7, v1
    s_sub_u32 s48, s53, 28
    s_lshl_b32 s48, s48, 3
    s_add_u32 s48, s48, s44
    s_lshr_b32 s50, s48, 4
    s_mul_i32 s50, s50, 917504
    s_and_b32 s48, s48, 15
    s_lshl_b32 s48, s48, 13
    s_add_u32 s48, s48, s50
    s_mov_b32 s51, s52
    s_cmp_ge_u32 s51, 7
    s_cselect_b32 s49, 7, 0
    s_sub_u32 s51, s51, s49
    s_lshl_b32 s49, s51, 17
    s_add_u32 s49, s49, s48
    s_add_u32 s51, s51, 1
    buffer_load_dword v7, v3, s[24:27], s49 offen
    s_cmp_ge_u32 s51, 7
    s_cselect_b32 s49, 7, 0
    s_sub_u32 s51, s51, s49
    s_lshl_b32 s49, s51, 17
    s_add_u32 s49, s49, s48
    s_add_u32 s51, s51, 1
    buffer_load_dword v7, v3, s[24:27], s49 offen
    s_cmp_ge_u32 s51, 7
    s_cselect_b32 s49, 7, 0
    s_sub_u32 s51, s51, s49
    s_lshl_b32 s49, s51, 17
    s_add_u32 s49, s49, s48
    s_add_u32 s51, s51, 1
    buffer_load_dword v7, v3, s[24:27], s49 offen
    s_cmp_ge_u32 s51, 7
    s_cselect_b32 s49, 7, 0
    s_sub_u32 s51, s51, s49
    s_lshl_b32 s49, s51, 17
    s_add_u32 s49, s49, s48
    s_add_u32 s51, s51, 1
    buffer_load_dword v7, v3, s[24:27], s49 offen
    s_cmp_ge_u32 s51, 7
    s_cselect_b32 s49, 7, 0
    s_sub_u32 s51, s51, s49
    s_lshl_b32 s49, s51, 17
    s_add_u32 s49, s49, s48
    s_add_u32 s51, s51, 1
    buffer_load_dword v7, v3, s[24:27], s49 offen
    s_cmp_ge_u32 s51, 7
    s_cselect_b32 s49, 7, 0
    s_sub_u32 s51, s51, s49
    s_lshl_b32 s49, s51, 17
    s_add_u32 s49, s49, s48
    s_add_u32 s51, s51, 1
    buffer_load_dword v7, v3, s[24:27], s49 offen
    s_cmp_ge_u32 s51, 7
    s_cselect_b32 s49, 7, 0
    s_sub_u32 s51, s51, s49
    s_lshl_b32 s49, s51, 17
    s_add_u32 s49, s49, s48
    s_add_u32 s51, s51, 1
    buffer_load_dword v7, v3, s[24:27], s49 offen
    s_cmp_ge_u32 s90, 7
    s_cselect_b32 s88, 7, 0
    s_sub_u32 s90, s90, s88
    s_lshl_b32 s88, s90, 17
    s_add_u32 s88, s88, s95
    s_add_u32 m0, s89, 65536
    s_add_u32 s90, s90, 2
    buffer_load_dwordx4 v12, s[24:27], s88 offen offset:0 lds
    buffer_load_dwordx4 v13, s[24:27], s88 offen offset:1024 lds
    buffer_load_dwordx4 v14, s[24:27], s88 offen offset:2048 lds
    buffer_load_dwordx4 v15, s[24:27], s88 offen offset:3072 lds
    s_cmp_ge_u32 s90, 7
    s_cselect_b32 s88, 7, 0
    s_sub_u32 s90, s90, s88
    s_lshl_b32 s88, s90, 17
    s_add_u32 s88, s88, s95
    s_add_u32 m0, s89, 98304
    s_add_u32 s90, s90, 2
    buffer_load_dwordx4 v12, s[24:27], s88 offen offset:0 lds
    buffer_load_dwordx4 v13, s[24:27], s88 offen offset:1024 lds
    buffer_load_dwordx4 v14, s[24:27], s88 offen offset:2048 lds
    buffer_load_dwordx4 v15, s[24:27], s88 offen offset:3072 lds
    s_waitcnt vmcnt(0) lgkmcnt(0)
    v_readfirstlane_b32 s46, v6
    s_mov_b32 s63, 0x80000000
P4_START:
    s_cmp_ge_u32 s44, 4
    s_cbranch_scc1 P4_HELP
    s_and_b32 s55, s45, 1
    s_lshr_b32 s56, s45, 1
    s_mov_b32 s57, s91
    v_bfe_u32 v3, v1, 3, 1
    v_xor_b32 v3, s56, v3
    v_lshlrev_b32 v16, 6, v3
    v_bfe_u32 v3, v1, 4, 1
    v_lshl_add_u32 v16, v3, 5, v16
    v_and_b32 v3, 1, v1
    v_lshl_add_u32 v16, v3, 4, v16
    v_bfe_u32 v3, v1, 1, 1
    v_lshl_add_u32 v16, v3, 3, v16
    v_bfe_u32 v3, v1, 2, 2
    v_lshl_add_u32 v16, v3, 7, v16
    v_lshrrev_b32 v3, 5, v1
    v_lshl_add_u32 v16, v3, 10, v16
    s_mul_i32 s48, s56, 8192
    v_add_u32 v16, s48, v16
    v_xor_b32 v17, 64, v16
    v_add_u32 v18, 65536, v16
    v_add_u32 v20, 131072, v16
    v_add_u32 v19, 65536, v17
    v_add_u32 v21, 131072, v17
    v_add_u32 v23, 4096, v2
    s_lshr_b32 s54, s92, 1
    s_lshl_b32 s54, s54, 17
    s_and_b32 s48, s92, 1
    s_lshl_b32 s48, s48, 10
    s_add_u32 s54, s54, s48
    v_and_b32 v3, 31, v1
    v_lshlrev_b32 v22, 11, v3
    v_lshrrev_b32 v3, 5, v1
    v_lshl_add_u32 v22, v3, 4, v22
    s_lshl_b32 s60, s55, 16
    s_add_u32 s60, s60, s54
    s_lshl_b32 s49, s93, 7
    s_add_u32 s60, s60, s49
    s_lshl_b32 s49, s56, 6
    s_add_u32 s60, s60, s49
    s_lshl_b32 s50, s92, 1
    s_add_u32 s50, s50, s55
    s_mul_i32 s58, s50, 114688
    s_mul_i32 s49, s56, 57344
    s_add_u32 s58, s58, s49
    s_add_u32 s58, s58, 4194304
    s_lshr_b32 s49, s95, 4
    s_add_u32 s58, s58, s49
    s_lshl_b32 s61, s50, 15
    s_lshl_b32 s49, s93, 12
    s_add_u32 s61, s61, s49
    s_lshl_b32 s49, s56, 11
    s_add_u32 s61, s61, s49
    s_add_u32 s61, s61, 2097152
    s_lshl_b32 s48, s44, 12
    s_add_u32 s48, s48, 0
    v_add_u32 v24, s48, v2
    v_xor_b32 v25, 8192, v24
    s_mov_b32 s28, s18
    s_and_b32 s29, s19, 0xffff
    s_mov_b32 s30, 0x200000
    s_mov_b32 s31, 0x20000
    v_mov_b32 v4, 1
    s_mov_b64 exec, 1
    s_waitcnt vmcnt(0)
    ds_add_rtn_u32 v5, v11, v4 offset:12
    s_waitcnt lgkmcnt(0)
    v_readfirstlane_b32 s48, v5
    s_mov_b64 exec, -1
    s_cmp_lg_u32 s48, 7
    s_cbranch_scc1 SIG_21
    v_mov_b32 v3, s46
    v_lshlrev_b32 v4, 28, v1
    buffer_store_dword v3, v4, s[40:43], s63 offen sc1
SIG_21:
    s_cmp_ge_u32 s90, 7
    s_cselect_b32 s88, 7, 0
    s_sub_u32 s90, s90, s88
    s_lshl_b32 s88, s90, 17
    s_add_u32 s88, s88, s95
    s_add_u32 m0, s89, 131072
    s_add_u32 s90, s90, 1
    buffer_load_dwordx4 v12, s[24:27], s88 offen offset:0 lds
    buffer_load_dwordx4 v13, s[24:27], s88 offen offset:1024 lds
    buffer_load_dwordx4 v14, s[24:27], s88 offen offset:2048 lds
    buffer_load_dwordx4 v15, s[24:27], s88 offen offset:3072 lds
    buffer_load_dwordx4 v[220:223], v2, s[40:43], s61 offen offset:0 sc1
    buffer_load_dwordx4 v[224:227], v2, s[40:43], s61 offen offset:1024 sc1
    s_barrier
    ds_read_b64_tr_b16 v[124:125], v18 offset:0
    ds_read_b64_tr_b16 v[126:127], v18 offset:512
    ds_read_b64_tr_b16 v[128:129], v19 offset:0
    ds_read_b64_tr_b16 v[130:131], v19 offset:512
    ds_read_b64_tr_b16 v[132:133], v18 offset:2048
    ds_read_b64_tr_b16 v[134:135], v18 offset:2560
    ds_read_b64_tr_b16 v[136:137], v19 offset:2048
    ds_read_b64_tr_b16 v[138:139], v19 offset:2560
    ds_read_b64_tr_b16 v[140:141], v18 offset:4096
    ds_read_b64_tr_b16 v[142:143], v18 offset:4608
    ds_read_b64_tr_b16 v[144:145], v19 offset:4096
    ds_read_b64_tr_b16 v[146:147], v19 offset:4608
    ds_read_b64_tr_b16 v[148:149], v18 offset:6144
    ds_read_b64_tr_b16 v[150:151], v18 offset:6656
    ds_read_b64_tr_b16 v[152:153], v19 offset:6144
    ds_read_b64_tr_b16 v[154:155], v19 offset:6656
    ds_read_b64_tr_b16 v[156:157], v18 offset:16384
    ds_read_b64_tr_b16 v[158:159], v18 offset:16896
    ds_read_b64_tr_b16 v[160:161], v19 offset:16384
    ds_read_b64_tr_b16 v[162:163], v19 offset:16896
    ds_read_b64_tr_b16 v[164:165], v18 offset:18432
    ds_read_b64_tr_b16 v[166:167], v18 offset:18944
    ds_read_b64_tr_b16 v[168:169], v19 offset:18432
    ds_read_b64_tr_b16 v[170:171], v19 offset:18944
    ds_read_b64_tr_b16 v[172:173], v18 offset:20480
    ds_read_b64_tr_b16 v[174:175], v18 offset:20992
    ds_read_b64_tr_b16 v[176:177], v19 offset:20480
    ds_read_b64_tr_b16 v[178:179], v19 offset:20992
    ds_read_b64_tr_b16 v[180:181], v18 offset:22528
    ds_read_b64_tr_b16 v[182:183], v18 offset:23040
    ds_read_b64_tr_b16 v[184:185], v19 offset:22528
    ds_read_b64_tr_b16 v[186:187], v19 offset:23040
    ds_read_b64_tr_b16 v[188:189], v18 offset:32768
    ds_read_b64_tr_b16 v[190:191], v18 offset:33280
    ds_read_b64_tr_b16 v[192:193], v19 offset:32768
    ds_read_b64_tr_b16 v[194:195], v19 offset:33280
    ds_read_b64_tr_b16 v[196:197], v18 offset:34816
    ds_read_b64_tr_b16 v[198:199], v18 offset:35328
    ds_read_b64_tr_b16 v[200:201], v19 offset:34816
    ds_read_b64_tr_b16 v[202:203], v19 offset:35328
    ds_read_b64_tr_b16 v[204:205], v18 offset:36864
    ds_read_b64_tr_b16 v[206:207], v18 offset:37376
    ds_read_b64_tr_b16 v[208:209], v19 offset:36864
    ds_read_b64_tr_b16 v[210:211], v19 offset:37376
    ds_read_b64_tr_b16 v[212:213], v18 offset:38912
    ds_read_b64_tr_b16 v[214:215], v18 offset:39424
    ds_read_b64_tr_b16 v[216:217], v19 offset:38912
    ds_read_b64_tr_b16 v[218:219], v19 offset:39424
    s_lshr_b32 s50, s92, 2
    s_mul_i32 s51, s50, 917504
    s_lshl_b32 s50, s50, 12
    s_add_u32 s50, s50, 14942208
    s_waitcnt lgkmcnt(0)
    s_barrier
    s_waitcnt vmcnt(0)
    v_lshlrev_b32 v28, 16, v220
    v_and_b32 v29, 0xffff0000, v220
    v_lshlrev_b32 v30, 16, v221
    v_and_b32 v31, 0xffff0000, v221
    v_lshlrev_b32 v32, 16, v222
    v_and_b32 v33, 0xffff0000, v222
    v_lshlrev_b32 v34, 16, v223
    v_and_b32 v35, 0xffff0000, v223
    v_lshlrev_b32 v36, 16, v224
    v_and_b32 v37, 0xffff0000, v224
    v_lshlrev_b32 v38, 16, v225
    v_and_b32 v39, 0xffff0000, v225
    v_lshlrev_b32 v40, 16, v226
    v_and_b32 v41, 0xffff0000, v226
    v_lshlrev_b32 v42, 16, v227
    v_and_b32 v43, 0xffff0000, v227
    v_and_b32 v3, 15, v1
    v_lshrrev_b32 v4, 5, v1
    v_lshlrev_b32 v4, 1, v4
    v_xor_b32 v3, v3, v4
    s_lshl_b32 s48, s56, 3
    v_xor_b32 v3, s48, v3
    v_lshlrev_b32 v228, 4, v3
    v_and_b32 v3, 31, v1
    v_lshl_add_u32 v228, v3, 8, v228
    s_lshl_b32 s48, s55, 14
    s_lshl_b32 s49, s56, 13
    s_add_u32 s49, s49, s48
    v_add_u32 v228, s49, v228
    v_xor_b32 v229, 16, v228
    v_xor_b32 v230, 64, v228
    v_xor_b32 v231, 80, v228
    v_xor_b32 v232, 128, v228
    v_xor_b32 v233, 144, v228
    v_xor_b32 v234, 192, v228
    v_xor_b32 v235, 208, v228
    v_lshrrev_b32 v3, 3, v1
    v_and_b32 v4, 7, v1
    v_lshlrev_b32 v5, 1, v4
    v_xor_b32 v5, v5, v3
    v_lshlrev_b32 v236, 4, v5
    v_lshl_add_u32 v236, v3, 8, v236
    s_lshl_b32 s49, s56, 12
    s_add_u32 s49, s49, s48
    v_add_u32 v236, s49, v236
    v_xor_b32 v237, 16, v236
    v_xor_b32 v238, 2176, v236
    v_xor_b32 v239, 2192, v236
    v_lshlrev_b32 v22, 4, v4
    v_lshl_add_u32 v22, v3, 11, v22
    s_mul_i32 s49, s56, 32704
    s_add_u32 s60, s60, s49
    s_add_u32 s61, s60, 16384
    s_cmp_lg_u32 s44, 0
    s_cbranch_scc1 P4_NOP
    v_min_u32 v10, 27, v1
    v_lshlrev_b32 v10, 7, v10
    s_mov_b32 s49, 0x40000
    buffer_load_dword v8, v10, s[40:43], s50 offen sc1
    s_sleep 4
POLL_22:
    buffer_load_dword v9, v10, s[40:43], s50 offen sc1
    s_waitcnt vmcnt(1)
    v_cmp_ne_u32 vcc, s46, v8
    s_nop 4
    s_cbranch_vccz POLLD_23
    buffer_load_dword v8, v10, s[40:43], s50 offen sc1
    s_waitcnt vmcnt(1)
    v_cmp_ne_u32 vcc, s46, v9
    s_nop 4
    s_cbranch_vccz POLLD_23
    s_sub_u32 s49, s49, 1
    s_cbranch_scc0 POLL_22
POLLD_23:
    s_branch P4_GO
P4_NOP:
P4_GO:
    s_barrier
    s_lshl_b32 s59, s57, 13
    s_add_u32 s59, s59, s58
    buffer_load_dwordx4 v[60:63], v2, s[40:43], s59 offen offset:0 sc1
    buffer_load_dwordx4 v[64:67], v2, s[40:43], s59 offen offset:1024 sc1
    s_add_u32 s57, s57, 1
    s_cmp_eq_u32 s57, 7
    s_cselect_b32 s57, 0, s57
    buffer_load_dwordx4 v[68:71], v23, s[40:43], s59 offen offset:0 sc1
    buffer_load_dwordx4 v[72:75], v23, s[40:43], s59 offen offset:1024 sc1
    s_lshl_b32 s59, s57, 13
    s_add_u32 s59, s59, s58
    buffer_load_dwordx4 v[76:79], v2, s[40:43], s59 offen offset:0 sc1
    buffer_load_dwordx4 v[80:83], v2, s[40:43], s59 offen offset:1024 sc1
    s_add_u32 s57, s57, 1
    s_cmp_eq_u32 s57, 7
    s_cselect_b32 s57, 0, s57
    buffer_load_dwordx4 v[84:87], v23, s[40:43], s59 offen offset:0 sc1
    buffer_load_dwordx4 v[88:91], v23, s[40:43], s59 offen offset:1024 sc1
    s_lshl_b32 s59, s57, 13
    s_add_u32 s59, s59, s58
    buffer_load_dwordx4 v[92:95], v2, s[40:43], s59 offen offset:0 sc1
    buffer_load_dwordx4 v[96:99], v2, s[40:43], s59 offen offset:1024 sc1
    s_add_u32 s57, s57, 1
    s_cmp_eq_u32 s57, 7
    s_cselect_b32 s57, 0, s57
    buffer_load_dwordx4 v[100:103], v23, s[40:43], s59 offen offset:0 sc1
    buffer_load_dwordx4 v[104:107], v23, s[40:43], s59 offen offset:1024 sc1
    s_waitcnt vmcnt(11) lgkmcnt(15)
    v_mfma_f32_32x32x16_bf16 v[44:59], v[128:131], v[60:63], 0
    ds_read_b64_tr_b16 v[128:129], v19 offset:49152
    ds_read_b64_tr_b16 v[130:131], v19 offset:49664
    v_mfma_f32_32x32x16_bf16 v[28:43], v[124:127], v[60:63], v[28:43]
    ds_read_b64_tr_b16 v[124:125], v18 offset:49152
    ds_read_b64_tr_b16 v[126:127], v18 offset:49664
    s_lshl_b32 s59, s57, 13
    s_add_u32 s59, s59, s58
    buffer_load_dwordx4 v[108:111], v2, s[40:43], s59 offen offset:0 sc1
    s_waitcnt vmcnt(11) lgkmcnt(15)
    v_mfma_f32_32x32x16_bf16 v[44:59], v[136:139], v[64:67], v[44:59]
    ds_read_b64_tr_b16 v[136:137], v19 offset:51200
    ds_read_b64_tr_b16 v[138:139], v19 offset:51712
    v_mfma_f32_32x32x16_bf16 v[28:43], v[132:135], v[64:67], v[28:43]
    ds_read_b64_tr_b16 v[132:133], v18 offset:51200
    ds_read_b64_tr_b16 v[134:135], v18 offset:51712
    buffer_load_dwordx4 v[112:115], v2, s[40:43], s59 offen offset:1024 sc1
    s_add_u32 s57, s57, 1
    s_cmp_eq_u32 s57, 7
    s_cselect_b32 s57, 0, s57
    s_waitcnt vmcnt(11) lgkmcnt(15)
    v_mfma_f32_32x32x16_bf16 v[44:59], v[144:147], v[68:71], v[44:59]
    ds_read_b64_tr_b16 v[144:145], v19 offset:53248
    ds_read_b64_tr_b16 v[146:147], v19 offset:53760
    v_mfma_f32_32x32x16_bf16 v[28:43], v[140:143], v[68:71], v[28:43]
    ds_read_b64_tr_b16 v[140:141], v18 offset:53248
    ds_read_b64_tr_b16 v[142:143], v18 offset:53760
    buffer_load_dwordx4 v[116:119], v23, s[40:43], s59 offen offset:0 sc1
    s_waitcnt vmcnt(11) lgkmcnt(15)
    v_mfma_f32_32x32x16_bf16 v[44:59], v[152:155], v[72:75], v[44:59]
    ds_read_b64_tr_b16 v[152:153], v19 offset:55296
    ds_read_b64_tr_b16 v[154:155], v19 offset:55808
    v_mfma_f32_32x32x16_bf16 v[28:43], v[148:151], v[72:75], v[28:43]
    ds_read_b64_tr_b16 v[148:149], v18 offset:55296
    ds_read_b64_tr_b16 v[150:151], v18 offset:55808
    buffer_load_dwordx4 v[120:123], v23, s[40:43], s59 offen offset:1024 sc1
    s_waitcnt vmcnt(11) lgkmcnt(15)
    v_mfma_f32_32x32x16_bf16 v[44:59], v[160:163], v[76:79], v[44:59]
    ds_read_b64_tr_b16 v[160:161], v21 offset:0
    ds_read_b64_tr_b16 v[162:163], v21 offset:512
    v_mfma_f32_32x32x16_bf16 v[28:43], v[156:159], v[76:79], v[28:43]
    ds_read_b64_tr_b16 v[156:157], v20 offset:0
    ds_read_b64_tr_b16 v[158:159], v20 offset:512
    s_lshl_b32 s59, s57, 13
    s_add_u32 s59, s59, s58
    buffer_load_dwordx4 v[60:63], v2, s[40:43], s59 offen offset:0 sc1
    s_waitcnt vmcnt(11) lgkmcnt(15)
    v_mfma_f32_32x32x16_bf16 v[44:59], v[168:171], v[80:83], v[44:59]
    ds_read_b64_tr_b16 v[168:169], v21 offset:2048
    ds_read_b64_tr_b16 v[170:171], v21 offset:2560
    v_mfma_f32_32x32x16_bf16 v[28:43], v[164:167], v[80:83], v[28:43]
    ds_read_b64_tr_b16 v[164:165], v20 offset:2048
    ds_read_b64_tr_b16 v[166:167], v20 offset:2560
    buffer_load_dwordx4 v[64:67], v2, s[40:43], s59 offen offset:1024 sc1
    s_add_u32 s57, s57, 1
    s_cmp_eq_u32 s57, 7
    s_cselect_b32 s57, 0, s57
    s_waitcnt vmcnt(11) lgkmcnt(15)
    v_mfma_f32_32x32x16_bf16 v[44:59], v[176:179], v[84:87], v[44:59]
    ds_read_b64_tr_b16 v[176:177], v21 offset:4096
    ds_read_b64_tr_b16 v[178:179], v21 offset:4608
    v_mfma_f32_32x32x16_bf16 v[28:43], v[172:175], v[84:87], v[28:43]
    ds_read_b64_tr_b16 v[172:173], v20 offset:4096
    ds_read_b64_tr_b16 v[174:175], v20 offset:4608
    buffer_load_dwordx4 v[68:71], v23, s[40:43], s59 offen offset:0 sc1
    s_waitcnt vmcnt(11) lgkmcnt(15)
    v_mfma_f32_32x32x16_bf16 v[44:59], v[184:187], v[88:91], v[44:59]
    ds_read_b64_tr_b16 v[184:185], v21 offset:6144
    ds_read_b64_tr_b16 v[186:187], v21 offset:6656
    v_mfma_f32_32x32x16_bf16 v[28:43], v[180:183], v[88:91], v[28:43]
    ds_read_b64_tr_b16 v[180:181], v20 offset:6144
    ds_read_b64_tr_b16 v[182:183], v20 offset:6656
    buffer_load_dwordx4 v[72:75], v23, s[40:43], s59 offen offset:1024 sc1
    s_waitcnt vmcnt(11) lgkmcnt(15)
    v_mfma_f32_32x32x16_bf16 v[44:59], v[192:195], v[92:95], v[44:59]
    ds_read_b64_tr_b16 v[192:193], v17 offset:0
    ds_read_b64_tr_b16 v[194:195], v17 offset:512
    v_mfma_f32_32x32x16_bf16 v[28:43], v[188:191], v[92:95], v[28:43]
    ds_read_b64_tr_b16 v[188:189], v16 offset:0
    ds_read_b64_tr_b16 v[190:191], v16 offset:512
    s_lshl_b32 s59, s57, 13
    s_add_u32 s59, s59, s58
    buffer_load_dwordx4 v[76:79], v2, s[40:43], s59 offen offset:0 sc1
    s_waitcnt vmcnt(11) lgkmcnt(15)
    v_mfma_f32_32x32x16_bf16 v[44:59], v[200:203], v[96:99], v[44:59]
    ds_read_b64_tr_b16 v[200:201], v17 offset:2048
    ds_read_b64_tr_b16 v[202:203], v17 offset:2560
    v_mfma_f32_32x32x16_bf16 v[28:43], v[196:199], v[96:99], v[28:43]
    ds_read_b64_tr_b16 v[196:197], v16 offset:2048
    ds_read_b64_tr_b16 v[198:199], v16 offset:2560
    buffer_load_dwordx4 v[80:83], v2, s[40:43], s59 offen offset:1024 sc1
    s_add_u32 s57, s57, 1
    s_cmp_eq_u32 s57, 7
    s_cselect_b32 s57, 0, s57
    s_waitcnt vmcnt(11) lgkmcnt(15)
    v_mfma_f32_32x32x16_bf16 v[44:59], v[208:211], v[100:103], v[44:59]
    ds_read_b64_tr_b16 v[208:209], v17 offset:4096
    ds_read_b64_tr_b16 v[210:211], v17 offset:4608
    v_mfma_f32_32x32x16_bf16 v[28:43], v[204:207], v[100:103], v[28:43]
    ds_read_b64_tr_b16 v[204:205], v16 offset:4096
    ds_read_b64_tr_b16 v[206:207], v16 offset:4608
    buffer_load_dwordx4 v[84:87], v23, s[40:43], s59 offen offset:0 sc1
    s_waitcnt vmcnt(11) lgkmcnt(15)
    v_mfma_f32_32x32x16_bf16 v[44:59], v[216:219], v[104:107], v[44:59]
    ds_read_b64_tr_b16 v[216:217], v17 offset:6144
    ds_read_b64_tr_b16 v[218:219], v17 offset:6656
    v_mfma_f32_32x32x16_bf16 v[28:43], v[212:215], v[104:107], v[28:43]
    ds_read_b64_tr_b16 v[212:213], v16 offset:6144
    ds_read_b64_tr_b16 v[214:215], v16 offset:6656
    buffer_load_dwordx4 v[88:91], v23, s[40:43], s59 offen offset:1024 sc1
    s_waitcnt vmcnt(11) lgkmcnt(15)
    v_mfma_f32_32x32x16_bf16 v[44:59], v[128:131], v[108:111], v[44:59]
    ds_read_b64_tr_b16 v[128:129], v17 offset:16384
    ds_read_b64_tr_b16 v[130:131], v17 offset:16896
    v_mfma_f32_32x32x16_bf16 v[28:43], v[124:127], v[108:111], v[28:43]
    ds_read_b64_tr_b16 v[124:125], v16 offset:16384
    ds_read_b64_tr_b16 v[126:127], v16 offset:16896
    s_lshl_b32 s59, s57, 13
    s_add_u32 s59, s59, s58
    buffer_load_dwordx4 v[92:95], v2, s[40:43], s59 offen offset:0 sc1
    s_waitcnt vmcnt(11) lgkmcnt(15)
    v_mfma_f32_32x32x16_bf16 v[44:59], v[136:139], v[112:115], v[44:59]
    ds_read_b64_tr_b16 v[136:137], v17 offset:18432
    ds_read_b64_tr_b16 v[138:139], v17 offset:18944
    v_mfma_f32_32x32x16_bf16 v[28:43], v[132:135], v[112:115], v[28:43]
    ds_read_b64_tr_b16 v[132:133], v16 offset:18432
    ds_read_b64_tr_b16 v[134:135], v16 offset:18944
    buffer_load_dwordx4 v[96:99], v2, s[40:43], s59 offen offset:1024 sc1
    s_add_u32 s57, s57, 1
    s_cmp_eq_u32 s57, 7
    s_cselect_b32 s57, 0, s57
    s_waitcnt vmcnt(11) lgkmcnt(15)
    v_mfma_f32_32x32x16_bf16 v[44:59], v[144:147], v[116:119], v[44:59]
    ds_read_b64_tr_b16 v[144:145], v17 offset:20480
    ds_read_b64_tr_b16 v[146:147], v17 offset:20992
    v_mfma_f32_32x32x16_bf16 v[28:43], v[140:143], v[116:119], v[28:43]
    ds_read_b64_tr_b16 v[140:141], v16 offset:20480
    ds_read_b64_tr_b16 v[142:143], v16 offset:20992
    buffer_load_dwordx4 v[100:103], v23, s[40:43], s59 offen offset:0 sc1
    s_waitcnt vmcnt(11) lgkmcnt(15)
    v_mfma_f32_32x32x16_bf16 v[44:59], v[152:155], v[120:123], v[44:59]
    ds_read_b64_tr_b16 v[152:153], v17 offset:22528
    ds_read_b64_tr_b16 v[154:155], v17 offset:23040
    v_mfma_f32_32x32x16_bf16 v[28:43], v[148:151], v[120:123], v[28:43]
    ds_read_b64_tr_b16 v[148:149], v16 offset:22528
    ds_read_b64_tr_b16 v[150:151], v16 offset:23040
    buffer_load_dwordx4 v[104:107], v23, s[40:43], s59 offen offset:1024 sc1
    s_waitcnt lgkmcnt(15)
    s_barrier
    s_waitcnt vmcnt(11) lgkmcnt(15)
    v_mfma_f32_32x32x16_bf16 v[44:59], v[160:163], v[60:63], v[44:59]
    ds_read_b64_tr_b16 v[160:161], v17 offset:32768
    ds_read_b64_tr_b16 v[162:163], v17 offset:33280
    v_mfma_f32_32x32x16_bf16 v[28:43], v[156:159], v[60:63], v[28:43]
    ds_read_b64_tr_b16 v[156:157], v16 offset:32768
    ds_read_b64_tr_b16 v[158:159], v16 offset:33280
    s_xor_b32 s58, s58, 2048
    s_lshl_b32 s59, s57, 13
    s_add_u32 s59, s59, s58
    buffer_load_dwordx4 v[108:111], v2, s[40:43], s59 offen offset:0 sc1
    s_waitcnt vmcnt(11) lgkmcnt(15)
    v_mfma_f32_32x32x16_bf16 v[44:59], v[168:171], v[64:67], v[44:59]
    ds_read_b64_tr_b16 v[168:169], v17 offset:34816
    ds_read_b64_tr_b16 v[170:171], v17 offset:35328
    v_mfma_f32_32x32x16_bf16 v[28:43], v[164:167], v[64:67], v[28:43]
    ds_read_b64_tr_b16 v[164:165], v16 offset:34816
    ds_read_b64_tr_b16 v[166:167], v16 offset:35328
    buffer_load_dwordx4 v[112:115], v2, s[40:43], s59 offen offset:1024 sc1
    s_add_u32 s57, s57, 1
    s_cmp_eq_u32 s57, 7
    s_cselect_b32 s57, 0, s57
    s_waitcnt vmcnt(11) lgkmcnt(15)
    v_mfma_f32_32x32x16_bf16 v[44:59], v[176:179], v[68:71], v[44:59]
    ds_read_b64_tr_b16 v[176:177], v17 offset:36864
    ds_read_b64_tr_b16 v[178:179], v17 offset:37376
    v_mfma_f32_32x32x16_bf16 v[28:43], v[172:175], v[68:71], v[28:43]
    ds_read_b64_tr_b16 v[172:173], v16 offset:36864
    ds_read_b64_tr_b16 v[174:175], v16 offset:37376
    buffer_load_dwordx4 v[116:119], v23, s[40:43], s59 offen offset:0 sc1
    s_waitcnt vmcnt(11) lgkmcnt(15)
    v_mfma_f32_32x32x16_bf16 v[44:59], v[184:187], v[72:75], v[44:59]
    ds_read_b64_tr_b16 v[184:185], v17 offset:38912
    ds_read_b64_tr_b16 v[186:187], v17 offset:39424
    v_mfma_f32_32x32x16_bf16 v[28:43], v[180:183], v[72:75], v[28:43]
    ds_read_b64_tr_b16 v[180:181], v16 offset:38912
    ds_read_b64_tr_b16 v[182:183], v16 offset:39424
    buffer_load_dwordx4 v[120:123], v23, s[40:43], s59 offen offset:1024 sc1
    s_waitcnt vmcnt(11) lgkmcnt(15)
    v_mfma_f32_32x32x16_bf16 v[44:59], v[192:195], v[76:79], v[44:59]
    ds_read_b64_tr_b16 v[192:193], v17 offset:49152
    ds_read_b64_tr_b16 v[194:195], v17 offset:49664
    v_mfma_f32_32x32x16_bf16 v[28:43], v[188:191], v[76:79], v[28:43]
    ds_read_b64_tr_b16 v[188:189], v16 offset:49152
    ds_read_b64_tr_b16 v[190:191], v16 offset:49664
    s_lshl_b32 s59, s57, 13
    s_add_u32 s59, s59, s58
    buffer_load_dwordx4 v[60:63], v2, s[40:43], s59 offen offset:0 sc1
    s_waitcnt vmcnt(11) lgkmcnt(15)
    v_mfma_f32_32x32x16_bf16 v[44:59], v[200:203], v[80:83], v[44:59]
    ds_read_b64_tr_b16 v[200:201], v17 offset:51200
    ds_read_b64_tr_b16 v[202:203], v17 offset:51712
    v_mfma_f32_32x32x16_bf16 v[28:43], v[196:199], v[80:83], v[28:43]
    ds_read_b64_tr_b16 v[196:197], v16 offset:51200
    ds_read_b64_tr_b16 v[198:199], v16 offset:51712
    buffer_load_dwordx4 v[64:67], v2, s[40:43], s59 offen offset:1024 sc1
    s_add_u32 s57, s57, 1
    s_cmp_eq_u32 s57, 7
    s_cselect_b32 s57, 0, s57
    s_waitcnt vmcnt(11) lgkmcnt(15)
    v_mfma_f32_32x32x16_bf16 v[44:59], v[208:211], v[84:87], v[44:59]
    ds_read_b64_tr_b16 v[208:209], v17 offset:53248
    ds_read_b64_tr_b16 v[210:211], v17 offset:53760
    v_mfma_f32_32x32x16_bf16 v[28:43], v[204:207], v[84:87], v[28:43]
    ds_read_b64_tr_b16 v[204:205], v16 offset:53248
    ds_read_b64_tr_b16 v[206:207], v16 offset:53760
    buffer_load_dwordx4 v[68:71], v23, s[40:43], s59 offen offset:0 sc1
    s_waitcnt vmcnt(11) lgkmcnt(15)
    v_mfma_f32_32x32x16_bf16 v[44:59], v[216:219], v[88:91], v[44:59]
    ds_read_b64_tr_b16 v[216:217], v17 offset:55296
    ds_read_b64_tr_b16 v[218:219], v17 offset:55808
    v_mfma_f32_32x32x16_bf16 v[28:43], v[212:215], v[88:91], v[28:43]
    ds_read_b64_tr_b16 v[212:213], v16 offset:55296
    ds_read_b64_tr_b16 v[214:215], v16 offset:55808
    buffer_load_dwordx4 v[72:75], v23, s[40:43], s59 offen offset:1024 sc1
    s_waitcnt vmcnt(11) lgkmcnt(15)
    v_mfma_f32_32x32x16_bf16 v[44:59], v[128:131], v[92:95], v[44:59]
    ds_read_b64_tr_b16 v[128:129], v19 offset:0
    ds_read_b64_tr_b16 v[130:131], v19 offset:512
    v_mfma_f32_32x32x16_bf16 v[28:43], v[124:127], v[92:95], v[28:43]
    ds_read_b64_tr_b16 v[124:125], v18 offset:0
    ds_read_b64_tr_b16 v[126:127], v18 offset:512
    s_lshl_b32 s59, s57, 13
    s_add_u32 s59, s59, s58
    buffer_load_dwordx4 v[76:79], v2, s[40:43], s59 offen offset:0 sc1
    s_waitcnt vmcnt(11) lgkmcnt(15)
    v_mfma_f32_32x32x16_bf16 v[44:59], v[136:139], v[96:99], v[44:59]
    ds_read_b64_tr_b16 v[136:137], v19 offset:2048
    ds_read_b64_tr_b16 v[138:139], v19 offset:2560
    v_mfma_f32_32x32x16_bf16 v[28:43], v[132:135], v[96:99], v[28:43]
    ds_read_b64_tr_b16 v[132:133], v18 offset:2048
    ds_read_b64_tr_b16 v[134:135], v18 offset:2560
    buffer_load_dwordx4 v[80:83], v2, s[40:43], s59 offen offset:1024 sc1
    s_add_u32 s57, s57, 1
    s_cmp_eq_u32 s57, 7
    s_cselect_b32 s57, 0, s57
    s_waitcnt vmcnt(11) lgkmcnt(15)
    v_mfma_f32_32x32x16_bf16 v[44:59], v[144:147], v[100:103], v[44:59]
    ds_read_b64_tr_b16 v[144:145], v19 offset:4096
    ds_read_b64_tr_b16 v[146:147], v19 offset:4608
    v_mfma_f32_32x32x16_bf16 v[28:43], v[140:143], v[100:103], v[28:43]
    ds_read_b64_tr_b16 v[140:141], v18 offset:4096
    ds_read_b64_tr_b16 v[142:143], v18 offset:4608
    buffer_load_dwordx4 v[84:87], v23, s[40:43], s59 offen offset:0 sc1
    s_waitcnt vmcnt(11) lgkmcnt(15)
    v_mfma_f32_32x32x16_bf16 v[44:59], v[152:155], v[104:107], v[44:59]
    ds_read_b64_tr_b16 v[152:153], v19 offset:6144
    ds_read_b64_tr_b16 v[154:155], v19 offset:6656
    v_mfma_f32_32x32x16_bf16 v[28:43], v[148:151], v[104:107], v[28:43]
    ds_read_b64_tr_b16 v[148:149], v18 offset:6144
    ds_read_b64_tr_b16 v[150:151], v18 offset:6656
    buffer_load_dwordx4 v[88:91], v23, s[40:43], s59 offen offset:1024 sc1
    s_waitcnt vmcnt(11) lgkmcnt(15)
    v_mfma_f32_32x32x16_bf16 v[44:59], v[160:163], v[108:111], v[44:59]
    ds_read_b64_tr_b16 v[160:161], v19 offset:16384
    ds_read_b64_tr_b16 v[162:163], v19 offset:16896
    v_mfma_f32_32x32x16_bf16 v[28:43], v[156:159], v[108:111], v[28:43]
    ds_read_b64_tr_b16 v[156:157], v18 offset:16384
    ds_read_b64_tr_b16 v[158:159], v18 offset:16896
    s_lshl_b32 s59, s57, 13
    s_add_u32 s59, s59, s58
    buffer_load_dwordx4 v[92:95], v2, s[40:43], s59 offen offset:0 sc1
    s_waitcnt vmcnt(11) lgkmcnt(15)
    v_mfma_f32_32x32x16_bf16 v[44:59], v[168:171], v[112:115], v[44:59]
    ds_read_b64_tr_b16 v[168:169], v19 offset:18432
    ds_read_b64_tr_b16 v[170:171], v19 offset:18944
    v_mfma_f32_32x32x16_bf16 v[28:43], v[164:167], v[112:115], v[28:43]
    ds_read_b64_tr_b16 v[164:165], v18 offset:18432
    ds_read_b64_tr_b16 v[166:167], v18 offset:18944
    buffer_load_dwordx4 v[96:99], v2, s[40:43], s59 offen offset:1024 sc1
    s_add_u32 s57, s57, 1
    s_cmp_eq_u32 s57, 7
    s_cselect_b32 s57, 0, s57
    s_waitcnt vmcnt(11) lgkmcnt(15)
    v_mfma_f32_32x32x16_bf16 v[44:59], v[176:179], v[116:119], v[44:59]
    ds_read_b64_tr_b16 v[176:177], v19 offset:20480
    ds_read_b64_tr_b16 v[178:179], v19 offset:20992
    v_mfma_f32_32x32x16_bf16 v[28:43], v[172:175], v[116:119], v[28:43]
    ds_read_b64_tr_b16 v[172:173], v18 offset:20480
    ds_read_b64_tr_b16 v[174:175], v18 offset:20992
    buffer_load_dwordx4 v[100:103], v23, s[40:43], s59 offen offset:0 sc1
    s_waitcnt vmcnt(11) lgkmcnt(15)
    v_mfma_f32_32x32x16_bf16 v[44:59], v[184:187], v[120:123], v[44:59]
    ds_read_b64_tr_b16 v[184:185], v19 offset:22528
    ds_read_b64_tr_b16 v[186:187], v19 offset:23040
    v_mfma_f32_32x32x16_bf16 v[28:43], v[180:183], v[120:123], v[28:43]
    ds_read_b64_tr_b16 v[180:181], v18 offset:22528
    ds_read_b64_tr_b16 v[182:183], v18 offset:23040
    buffer_load_dwordx4 v[104:107], v23, s[40:43], s59 offen offset:1024 sc1
    s_waitcnt vmcnt(11) lgkmcnt(15)
    v_mfma_f32_32x32x16_bf16 v[44:59], v[192:195], v[60:63], v[44:59]
    ds_read_b64_tr_b16 v[192:193], v19 offset:32768
    ds_read_b64_tr_b16 v[194:195], v19 offset:33280
    v_mfma_f32_32x32x16_bf16 v[28:43], v[188:191], v[60:63], v[28:43]
    ds_read_b64_tr_b16 v[188:189], v18 offset:32768
    ds_read_b64_tr_b16 v[190:191], v18 offset:33280
    s_lshl_b32 s59, s57, 13
    s_add_u32 s59, s59, s58
    buffer_load_dwordx4 v[108:111], v2, s[40:43], s59 offen offset:0 sc1
    s_waitcnt vmcnt(11) lgkmcnt(15)
    v_mfma_f32_32x32x16_bf16 v[44:59], v[200:203], v[64:67], v[44:59]
    ds_read_b64_tr_b16 v[200:201], v19 offset:34816
    ds_read_b64_tr_b16 v[202:203], v19 offset:35328
    v_mfma_f32_32x32x16_bf16 v[28:43], v[196:199], v[64:67], v[28:43]
    ds_read_b64_tr_b16 v[196:197], v18 offset:34816
    ds_read_b64_tr_b16 v[198:199], v18 offset:35328
    buffer_load_dwordx4 v[112:115], v2, s[40:43], s59 offen offset:1024 sc1
    s_add_u32 s57, s57, 1
    s_cmp_eq_u32 s57, 7
    s_cselect_b32 s57, 0, s57
    s_waitcnt vmcnt(11) lgkmcnt(15)
    v_mfma_f32_32x32x16_bf16 v[44:59], v[208:211], v[68:71], v[44:59]
    ds_read_b64_tr_b16 v[208:209], v19 offset:36864
    ds_read_b64_tr_b16 v[210:211], v19 offset:37376
    v_mfma_f32_32x32x16_bf16 v[28:43], v[204:207], v[68:71], v[28:43]
    ds_read_b64_tr_b16 v[204:205], v18 offset:36864
    ds_read_b64_tr_b16 v[206:207], v18 offset:37376
    buffer_load_dwordx4 v[116:119], v23, s[40:43], s59 offen offset:0 sc1
    s_waitcnt vmcnt(11) lgkmcnt(15)
    v_mfma_f32_32x32x16_bf16 v[44:59], v[216:219], v[72:75], v[44:59]
    ds_read_b64_tr_b16 v[216:217], v19 offset:38912
    ds_read_b64_tr_b16 v[218:219], v19 offset:39424
    v_mfma_f32_32x32x16_bf16 v[28:43], v[212:215], v[72:75], v[28:43]
    ds_read_b64_tr_b16 v[212:213], v18 offset:38912
    ds_read_b64_tr_b16 v[214:215], v18 offset:39424
    buffer_load_dwordx4 v[120:123], v23, s[40:43], s59 offen offset:1024 sc1
    s_waitcnt lgkmcnt(15)
    s_barrier
    s_waitcnt vmcnt(11) lgkmcnt(15)
    v_mfma_f32_32x32x16_bf16 v[44:59], v[128:131], v[76:79], v[44:59]
    ds_read_b64_tr_b16 v[128:129], v19 offset:49152
    ds_read_b64_tr_b16 v[130:131], v19 offset:49664
    v_mfma_f32_32x32x16_bf16 v[28:43], v[124:127], v[76:79], v[28:43]
    ds_read_b64_tr_b16 v[124:125], v18 offset:49152
    ds_read_b64_tr_b16 v[126:127], v18 offset:49664
    s_lshl_b32 s59, s57, 13
    s_add_u32 s59, s59, s58
    buffer_load_dwordx4 v[60:63], v2, s[40:43], s59 offen offset:0 sc1
    s_waitcnt vmcnt(11) lgkmcnt(15)
    v_mfma_f32_32x32x16_bf16 v[44:59], v[136:139], v[80:83], v[44:59]
    ds_read_b64_tr_b16 v[136:137], v19 offset:51200
    ds_read_b64_tr_b16 v[138:139], v19 offset:51712
    v_mfma_f32_32x32x16_bf16 v[28:43], v[132:135], v[80:83], v[28:43]
    ds_read_b64_tr_b16 v[132:133], v18 offset:51200
    ds_read_b64_tr_b16 v[134:135], v18 offset:51712
    buffer_load_dwordx4 v[64:67], v2, s[40:43], s59 offen offset:1024 sc1
    s_add_u32 s57, s57, 1
    s_cmp_eq_u32 s57, 7
    s_cselect_b32 s57, 0, s57
    s_waitcnt vmcnt(11) lgkmcnt(15)
    v_mfma_f32_32x32x16_bf16 v[44:59], v[144:147], v[84:87], v[44:59]
    ds_read_b64_tr_b16 v[144:145], v19 offset:53248
    ds_read_b64_tr_b16 v[146:147], v19 offset:53760
    v_mfma_f32_32x32x16_bf16 v[28:43], v[140:143], v[84:87], v[28:43]
    ds_read_b64_tr_b16 v[140:141], v18 offset:53248
    ds_read_b64_tr_b16 v[142:143], v18 offset:53760
    buffer_load_dwordx4 v[68:71], v23, s[40:43], s59 offen offset:0 sc1
    s_waitcnt vmcnt(11) lgkmcnt(15)
    v_mfma_f32_32x32x16_bf16 v[44:59], v[152:155], v[88:91], v[44:59]
    ds_read_b64_tr_b16 v[152:153], v19 offset:55296
    ds_read_b64_tr_b16 v[154:155], v19 offset:55808
    v_mfma_f32_32x32x16_bf16 v[28:43], v[148:151], v[88:91], v[28:43]
    ds_read_b64_tr_b16 v[148:149], v18 offset:55296
    ds_read_b64_tr_b16 v[150:151], v18 offset:55808
    buffer_load_dwordx4 v[72:75], v23, s[40:43], s59 offen offset:1024 sc1
    s_waitcnt vmcnt(11) lgkmcnt(15)
    v_mfma_f32_32x32x16_bf16 v[44:59], v[160:163], v[92:95], v[44:59]
    ds_read_b64_tr_b16 v[160:161], v21 offset:0
    ds_read_b64_tr_b16 v[162:163], v21 offset:512
    v_mfma_f32_32x32x16_bf16 v[28:43], v[156:159], v[92:95], v[28:43]
    ds_read_b64_tr_b16 v[156:157], v20 offset:0
    ds_read_b64_tr_b16 v[158:159], v20 offset:512
    s_lshl_b32 s59, s57, 13
    s_add_u32 s59, s59, s58
    buffer_load_dwordx4 v[76:79], v2, s[40:43], s59 offen offset:0 sc1
    s_waitcnt vmcnt(11) lgkmcnt(15)
    v_mfma_f32_32x32x16_bf16 v[44:59], v[168:171], v[96:99], v[44:59]
    ds_read_b64_tr_b16 v[168:169], v21 offset:2048
    ds_read_b64_tr_b16 v[170:171], v21 offset:2560
    v_mfma_f32_32x32x16_bf16 v[28:43], v[164:167], v[96:99], v[28:43]
    ds_read_b64_tr_b16 v[164:165], v20 offset:2048
    ds_read_b64_tr_b16 v[166:167], v20 offset:2560
    buffer_load_dwordx4 v[80:83], v2, s[40:43], s59 offen offset:1024 sc1
    s_add_u32 s57, s57, 1
    s_cmp_eq_u32 s57, 7
    s_cselect_b32 s57, 0, s57
    s_waitcnt vmcnt(11) lgkmcnt(15)
    v_mfma_f32_32x32x16_bf16 v[44:59], v[176:179], v[100:103], v[44:59]
    ds_read_b64_tr_b16 v[176:177], v21 offset:4096
    ds_read_b64_tr_b16 v[178:179], v21 offset:4608
    v_mfma_f32_32x32x16_bf16 v[28:43], v[172:175], v[100:103], v[28:43]
    ds_read_b64_tr_b16 v[172:173], v20 offset:4096
    ds_read_b64_tr_b16 v[174:175], v20 offset:4608
    buffer_load_dwordx4 v[84:87], v23, s[40:43], s59 offen offset:0 sc1
    s_waitcnt vmcnt(11) lgkmcnt(15)
    v_mfma_f32_32x32x16_bf16 v[44:59], v[184:187], v[104:107], v[44:59]
    ds_read_b64_tr_b16 v[184:185], v21 offset:6144
    ds_read_b64_tr_b16 v[186:187], v21 offset:6656
    v_mfma_f32_32x32x16_bf16 v[28:43], v[180:183], v[104:107], v[28:43]
    ds_read_b64_tr_b16 v[180:181], v20 offset:6144
    ds_read_b64_tr_b16 v[182:183], v20 offset:6656
    buffer_load_dwordx4 v[88:91], v23, s[40:43], s59 offen offset:1024 sc1
    s_waitcnt vmcnt(11) lgkmcnt(15)
    v_mfma_f32_32x32x16_bf16 v[44:59], v[192:195], v[108:111], v[44:59]
    v_mfma_f32_32x32x16_bf16 v[28:43], v[188:191], v[108:111], v[28:43]
    s_waitcnt vmcnt(10) lgkmcnt(15)
    v_mfma_f32_32x32x16_bf16 v[44:59], v[200:203], v[112:115], v[44:59]
    v_mfma_f32_32x32x16_bf16 v[28:43], v[196:199], v[112:115], v[28:43]
    s_waitcnt vmcnt(9) lgkmcnt(15)
    v_mfma_f32_32x32x16_bf16 v[44:59], v[208:211], v[116:119], v[44:59]
    v_mfma_f32_32x32x16_bf16 v[28:43], v[204:207], v[116:119], v[28:43]
    s_waitcnt vmcnt(8) lgkmcnt(15)
    v_mfma_f32_32x32x16_bf16 v[44:59], v[216:219], v[120:123], v[44:59]
    v_mfma_f32_32x32x16_bf16 v[28:43], v[212:215], v[120:123], v[28:43]
    s_waitcnt vmcnt(7) lgkmcnt(0)
    v_mfma_f32_32x32x16_bf16 v[44:59], v[128:131], v[60:63], v[44:59]
    v_mfma_f32_32x32x16_bf16 v[28:43], v[124:127], v[60:63], v[28:43]
    s_waitcnt vmcnt(6) lgkmcnt(0)
    v_mfma_f32_32x32x16_bf16 v[44:59], v[136:139], v[64:67], v[44:59]
    v_mfma_f32_32x32x16_bf16 v[28:43], v[132:135], v[64:67], v[28:43]
    s_waitcnt vmcnt(5) lgkmcnt(0)
    v_mfma_f32_32x32x16_bf16 v[44:59], v[144:147], v[68:71], v[44:59]
    v_mfma_f32_32x32x16_bf16 v[28:43], v[140:143], v[68:71], v[28:43]
    s_waitcnt vmcnt(4) lgkmcnt(0)
    v_mfma_f32_32x32x16_bf16 v[44:59], v[152:155], v[72:75], v[44:59]
    v_mfma_f32_32x32x16_bf16 v[28:43], v[148:151], v[72:75], v[28:43]
    s_waitcnt vmcnt(3) lgkmcnt(0)
    v_mfma_f32_32x32x16_bf16 v[44:59], v[160:163], v[76:79], v[44:59]
    v_mfma_f32_32x32x16_bf16 v[28:43], v[156:159], v[76:79], v[28:43]
    s_waitcnt vmcnt(2) lgkmcnt(0)
    v_mfma_f32_32x32x16_bf16 v[44:59], v[168:171], v[80:83], v[44:59]
    v_mfma_f32_32x32x16_bf16 v[28:43], v[164:167], v[80:83], v[28:43]
    s_waitcnt vmcnt(1) lgkmcnt(0)
    v_mfma_f32_32x32x16_bf16 v[44:59], v[176:179], v[84:87], v[44:59]
    v_mfma_f32_32x32x16_bf16 v[28:43], v[172:175], v[84:87], v[28:43]
    s_waitcnt vmcnt(0) lgkmcnt(0)
    v_mfma_f32_32x32x16_bf16 v[44:59], v[184:187], v[88:91], v[44:59]
    v_mfma_f32_32x32x16_bf16 v[28:43], v[180:183], v[88:91], v[28:43]
    s_nop 10
    ds_write_b128 v232, v[44:47]
    ds_write_b128 v233, v[48:51]
    ds_write_b128 v234, v[52:55]
    ds_write_b128 v235, v[56:59]
    ds_write_b128 v228, v[28:31]
    ds_write_b128 v229, v[32:35]
    ds_write_b128 v230, v[36:39]
    ds_write_b128 v231, v[40:43]
    s_lshl_b32 s48, s44, 2
    s_add_u32 s48, s48, 152640
    v_mov_b32 v3, s48
    v_mov_b32 v4, 1
    ds_write_b32 v3, v4
    v_xor_b32 v3, 8, v3
EXS_24:
    ds_read_b32 v5, v3
    ds_read_b128 v[124:127], v236 offset:0
    ds_read_b128 v[128:131], v236 offset:8192
    ds_read_b128 v[132:135], v237 offset:0
    ds_read_b128 v[136:139], v237 offset:8192
    ds_read_b128 v[140:143], v238 offset:0
    ds_read_b128 v[144:147], v238 offset:8192
    ds_read_b128 v[148:151], v239 offset:0
    ds_read_b128 v[152:155], v239 offset:8192
    s_waitcnt lgkmcnt(8)
    v_readfirstlane_b32 s48, v5
    s_nop 0
    s_cmp_eq_u32 s48, 0
    s_cbranch_scc1 EXS_24
    s_waitcnt lgkmcnt(6)
    v_pk_add_f32 v[124:125], v[124:125], v[128:129]
    v_pk_add_f32 v[126:127], v[126:127], v[130:131]
    v_cvt_pk_bf16_f32 v220, v124, v125
    v_cvt_pk_bf16_f32 v221, v126, v127
    s_waitcnt lgkmcnt(4)
    v_pk_add_f32 v[132:133], v[132:133], v[136:137]
    v_pk_add_f32 v[134:135], v[134:135], v[138:139]
    v_cvt_pk_bf16_f32 v222, v132, v133
    v_cvt_pk_bf16_f32 v223, v134, v135
    buffer_store_dwordx4 v[220:223], v22, s[28:31], s60 offen sc1
    s_waitcnt lgkmcnt(2)
    v_pk_add_f32 v[140:141], v[140:141], v[144:145]
    v_pk_add_f32 v[142:143], v[142:143], v[146:147]
    v_cvt_pk_bf16_f32 v224, v140, v141
    v_cvt_pk_bf16_f32 v225, v142, v143
    s_waitcnt lgkmcnt(0)
    v_pk_add_f32 v[148:149], v[148:149], v[152:153]
    v_pk_add_f32 v[150:151], v[150:151], v[154:155]
    v_cvt_pk_bf16_f32 v226, v148, v149
    v_cvt_pk_bf16_f32 v227, v150, v151
    buffer_store_dwordx4 v[224:227], v22, s[28:31], s61 offen sc1
    s_branch K_END
P4_HELP:
    s_sub_u32 s89, s89, 16384
    v_mov_b32 v4, 1
    s_mov_b64 exec, 1
    s_waitcnt vmcnt(0)
    ds_add_rtn_u32 v5, v11, v4 offset:12
    s_waitcnt lgkmcnt(0)
    v_readfirstlane_b32 s48, v5
    s_mov_b64 exec, -1
    s_cmp_lg_u32 s48, 7
    s_cbranch_scc1 SIG_25
    v_mov_b32 v3, s46
    v_lshlrev_b32 v4, 28, v1
    buffer_store_dword v3, v4, s[40:43], s63 offen sc1
SIG_25:
    s_add_u32 s90, s91, 5
    s_barrier
    s_cmp_ge_u32 s90, 7
    s_cselect_b32 s88, 7, 0
    s_sub_u32 s90, s90, s88
    s_lshl_b32 s88, s90, 17
    s_add_u32 s88, s88, s95
    s_add_u32 m0, s89, 0
    s_add_u32 s90, s90, 1
    buffer_load_dwordx4 v12, s[24:27], s88 offen offset:0 lds
    buffer_load_dwordx4 v13, s[24:27], s88 offen offset:1024 lds
    buffer_load_dwordx4 v14, s[24:27], s88 offen offset:2048 lds
    buffer_load_dwordx4 v15, s[24:27], s88 offen offset:3072 lds
    s_cmp_ge_u32 s90, 7
    s_cselect_b32 s88, 7, 0
    s_sub_u32 s90, s90, s88
    s_lshl_b32 s88, s90, 17
    s_add_u32 s88, s88, s95
    s_add_u32 m0, s89, 16384
    s_add_u32 s90, s90, 1
    buffer_load_dwordx4 v12, s[24:27], s88 offen offset:0 lds
    buffer_load_dwordx4 v13, s[24:27], s88 offen offset:1024 lds
    buffer_load_dwordx4 v14, s[24:27], s88 offen offset:2048 lds
    buffer_load_dwordx4 v15, s[24:27], s88 offen offset:3072 lds
    s_barrier
    s_cmp_ge_u32 s90, 7
    s_cselect_b32 s88, 7, 0
    s_sub_u32 s90, s90, s88
    s_lshl_b32 s88, s90, 17
    s_add_u32 s88, s88, s95
    s_xor_b32 s88, s88, 32768
    s_add_u32 m0, s89, 32768
    s_add_u32 s90, s90, 1
    buffer_load_dwordx4 v12, s[24:27], s88 offen offset:0 lds
    buffer_load_dwordx4 v13, s[24:27], s88 offen offset:1024 lds
    buffer_load_dwordx4 v14, s[24:27], s88 offen offset:2048 lds
    buffer_load_dwordx4 v15, s[24:27], s88 offen offset:3072 lds
    s_cmp_ge_u32 s90, 7
    s_cselect_b32 s88, 7, 0
    s_sub_u32 s90, s90, s88
    s_lshl_b32 s88, s90, 17
    s_add_u32 s88, s88, s95
    s_xor_b32 s88, s88, 32768
    s_add_u32 m0, s89, 49152
    s_add_u32 s90, s90, 1
    buffer_load_dwordx4 v12, s[24:27], s88 offen offset:0 lds
    buffer_load_dwordx4 v13, s[24:27], s88 offen offset:1024 lds
    buffer_load_dwordx4 v14, s[24:27], s88 offen offset:2048 lds
    buffer_load_dwordx4 v15, s[24:27], s88 offen offset:3072 lds
    s_cmp_ge_u32 s90, 7
    s_cselect_b32 s88, 7, 0
    s_sub_u32 s90, s90, s88
    s_lshl_b32 s88, s90, 17
    s_add_u32 s88, s88, s95
    s_xor_b32 s88, s88, 32768
    s_add_u32 m0, s89, 65536
    s_add_u32 s90, s90, 1
    buffer_load_dwordx4 v12, s[24:27], s88 offen offset:0 lds
    buffer_load_dwordx4 v13, s[24:27], s88 offen offset:1024 lds
    buffer_load_dwordx4 v14, s[24:27], s88 offen offset:2048 lds
    buffer_load_dwordx4 v15, s[24:27], s88 offen offset:3072 lds
    s_cmp_ge_u32 s90, 7
    s_cselect_b32 s88, 7, 0
    s_sub_u32 s90, s90, s88
    s_lshl_b32 s88, s90, 17
    s_add_u32 s88, s88, s95
    s_xor_b32 s88, s88, 32768
    s_add_u32 m0, s89, 81920
    s_add_u32 s90, s90, 1
    buffer_load_dwordx4 v12, s[24:27], s88 offen offset:0 lds
    buffer_load_dwordx4 v13, s[24:27], s88 offen offset:1024 lds
    buffer_load_dwordx4 v14, s[24:27], s88 offen offset:2048 lds
    buffer_load_dwordx4 v15, s[24:27], s88 offen offset:3072 lds
    s_cmp_ge_u32 s90, 7
    s_cselect_b32 s88, 7, 0
    s_sub_u32 s90, s90, s88
    s_lshl_b32 s88, s90, 17
    s_add_u32 s88, s88, s95
    s_xor_b32 s88, s88, 32768
    s_add_u32 m0, s89, 98304
    s_add_u32 s90, s90, 1
    buffer_load_dwordx4 v12, s[24:27], s88 offen offset:0 lds
    buffer_load_dwordx4 v13, s[24:27], s88 offen offset:1024 lds
    buffer_load_dwordx4 v14, s[24:27], s88 offen offset:2048 lds
    buffer_load_dwordx4 v15, s[24:27], s88 offen offset:3072 lds
    s_waitcnt vmcnt(20)
    s_barrier
    s_setprio 3
    s_waitcnt vmcnt(0)
    s_barrier
    s_cmp_ge_u32 s90, 7
    s_cselect_b32 s88, 7, 0
    s_sub_u32 s90, s90, s88
    s_lshl_b32 s88, s90, 17
    s_add_u32 s88, s88, s95
    s_xor_b32 s88, s88, 32768
    s_add_u32 m0, s89, 114688
    s_add_u32 s90, s90, 1
    buffer_load_dwordx4 v12, s[24:27], s88 offen offset:0 lds
    buffer_load_dwordx4 v13, s[24:27], s88 offen offset:1024 lds
    buffer_load_dwordx4 v14, s[24:27], s88 offen offset:2048 lds
    buffer_load_dwordx4 v15, s[24:27], s88 offen offset:3072 lds
    s_cmp_ge_u32 s90, 7
    s_cselect_b32 s88, 7, 0
    s_sub_u32 s90, s90, s88
    s_lshl_b32 s88, s90, 17
    s_add_u32 s88, s88, s95
    s_xor_b32 s88, s88, 32768
    s_add_u32 m0, s89, 131072
    s_add_u32 s90, s90, 1
    buffer_load_dwordx4 v12, s[24:27], s88 offen offset:0 lds
    buffer_load_dwordx4 v13, s[24:27], s88 offen offset:1024 lds
    buffer_load_dwordx4 v14, s[24:27], s88 offen offset:2048 lds
    buffer_load_dwordx4 v15, s[24:27], s88 offen offset:3072 lds
    s_waitcnt vmcnt(0)
    s_barrier
K_END:
    s_endpgm

.section .rodata,"a"
.p2align 6
.amdhsa_kernel sequential_preLN__sliding_local_dilated__glu_gated_swiglu__prompt_kernel
  .amdhsa_next_free_vgpr 256
  .amdhsa_next_free_sgpr 102
  .amdhsa_accum_offset 256
  .amdhsa_group_segment_fixed_size 0
  .amdhsa_kernarg_size 80
  .amdhsa_user_sgpr_count 2
  .amdhsa_user_sgpr_kernarg_segment_ptr 1
  .amdhsa_system_sgpr_workgroup_id_x 1
.end_amdhsa_kernel
```
